```python
import torch

def _softmax(x, axis=-1):
    return torch.softmax(x, dim=axis)
def _gelu(x):
    return torch.nn.functional.gelu(x, approximate="tanh")
def _silu(x):
    return torch.nn.functional.silu(x)
def _sigmoid(x):
    return torch.sigmoid(x)
def _layernorm(x, axis=-1, eps=1e-5):
    m = x.mean(dim=axis, keepdim=True)
    v = x.var(dim=axis, keepdim=True, unbiased=False)
    return (x - m) / torch.sqrt(v + eps)
def _scatter_add(tgt, idx, src, axis=0):
    return tgt.clone().index_add_(axis, idx, src)
def _segment_sum(src, seg, n):
    out = torch.zeros((n,) + src.shape[1:], dtype=src.dtype)
    return out.index_add_(0, seg, src)
def _pad(x, pw):
    flat = tuple(v for pair in reversed(pw) for v in pair)
    return torch.nn.functional.pad(x, flat)

kernel_name = 'sequential_preLN__mha_block__moe_arch_mod__prompt'

def setup_inputs():

    _w = (lambda a: (lambda t: t.to(torch.bfloat16) if t.is_floating_point() else t)(torch.as_tensor(a)))
    def _A_setup():
        B, S, D, H = 1, 2048, 576, 32
        return {
            "x": _w((lambda *s: torch.randn(*s, dtype=torch.bfloat16) * 0.05)(B, S, D)),
            "wqkv": _w((lambda *s: torch.randn(*s, dtype=torch.bfloat16) * 0.05)(D, 3 * D)),
            "wo": _w((lambda *s: torch.randn(*s, dtype=torch.bfloat16) * 0.05)(D, D)),
        }
    _A_in = _A_setup()

    def _B_setup():
        B, S, D, F, C = 1, 2048, 576, 4608, 1
        return {
            "x": _w((lambda *s: torch.randn(*s, dtype=torch.bfloat16) * 0.05)(B, S, D)),
            "w_r": _w((lambda *s: torch.randn(*s, dtype=torch.bfloat16) * 0.05)(D)),
            "w_gate": _w((lambda *s: torch.randn(*s, dtype=torch.bfloat16) * 0.05)(D, F)),
            "w_up": _w((lambda *s: torch.randn(*s, dtype=torch.bfloat16) * 0.05)(D, F)),
            "w_down": _w((lambda *s: torch.randn(*s, dtype=torch.bfloat16) * 0.05)(F, D)),
        }
    _B_in = _B_setup()

    return {
        "A_x": _A_in["x"],
        "A_wqkv": _A_in["wqkv"],
        "A_wo": _A_in["wo"],
        "B_x": _B_in["x"],
        "B_w_r": _B_in["w_r"],
        "B_w_gate": _B_in["w_gate"],
        "B_w_up": _B_in["w_up"],
        "B_w_down": _B_in["w_down"],
    }

def reference(A_x, A_wqkv, A_wo, B_x, B_w_r, B_w_gate, B_w_up, B_w_down):
    def _A_ref(x, wqkv, wo):
        B, S, D = x.shape
        H = 32
        Dh = D // H
        qkv = (lambda x, *d: x.permute(*d))((x @ wqkv).reshape(B, S, 3, H, Dh), 2, 0, 3, 1, 4)
        q, k, v = qkv[0], qkv[1], qkv[2]
        scores = torch.einsum("bhqd,bhkd->bhqk", q, k) * (Dh ** -0.5)
        p = _softmax(scores, axis=-1)
        o = torch.einsum("bhqk,bhkd->bhqd", p, v)
        return (lambda x, *d: x.permute(*d))(o, 0, 2, 1, 3).reshape(B, S, D) @ wo

    def _B_ref(x, w_r, w_gate, w_up, w_down):
        B, S, D = x.shape
        C = 1
        r = x @ w_r
        idx = torch.argsort(-r, axis=-1)[:, :C]
        idx_e = (lambda x, n, axis: torch.repeat_interleave(x, n, dim=axis))(idx.reshape(B, C, 1), D, axis=2)
        x_sel = (lambda x, i, axis: torch.take_along_dim(x, i, dim=axis))(x, idx_e, axis=1)
        g = _silu(x_sel @ w_gate)
        u = x_sel @ w_up
        y = (g * u) @ w_down
        r_sel = _sigmoid((lambda x, i, axis: torch.take_along_dim(x, i, dim=axis))(r, idx, axis=1))
        y = y * r_sel.reshape(B, C, 1)
        b_off = (torch.arange(B) * S).reshape(B, 1)
        flat_idx = (idx + b_off).reshape(B * C)
        zero = (x * 0.0).reshape(B * S, D)
        upd = _scatter_add(zero, flat_idx, y.reshape(B * C, D), axis=0)
        return x + upd.reshape(B, S, D)

    x = A_x
    h = x + _A_ref(_layernorm(x, axis=-1), A_wqkv, A_wo)
    h2 = h + _B_ref(_layernorm(h, axis=-1), B_w_r, B_w_gate, B_w_up, B_w_down)
    return h2
```

```asm
; @launch kernel=k1_kernel grid=(256,1,1) block=(512,1,1) lds=131072
; @launch kernel=k2_kernel grid=(256,1,1) block=(512,1,1) lds=155648
; @launch kernel=k3_kernel grid=(512,1,1) block=(256,1,1) lds=77824
.amdgcn_target "amdgcn-amd-amdhsa--gfx950"
.text
.globl k1_kernel
.p2align 8
.type k1_kernel,@function
k1_kernel:
  s_cmp_ge_u32 s2, 256
  s_cbranch_scc1 k1_end
  s_load_dwordx4 s[4:7], s[0:1], 0
  s_load_dwordx4 s[12:15], s[0:1], 72
  v_lshrrev_b32 v22, 6, v0
  v_and_b32 v1, 63, v0
  v_readfirstlane_b32 s38, v22
  v_and_b32 v2, 31, v0
  v_bfe_u32 v3, v0, 5, 1
  s_and_b32 s36, s2, 7
  s_lshl_b32 s36, s36, 1
  s_bfe_u32 s46, s2, 0x10003
  s_add_u32 s36, s36, s46
  s_lshr_b32 s37, s2, 4
  s_mov_b32 s47, 0x3f803f80
  s_mul_i32 s50, s37, 216
  s_sub_u32 s46, s37, 11
  s_lshl_b32 s46, s46, 8
  s_add_u32 s46, s46, 2304
  s_cmp_ge_u32 s37, 11
  s_cselect_b32 s50, s46, s50
  s_cselect_b32 s48, 1, 0
  s_lshr_b32 s67, s38, 2
  s_and_b32 s38, s38, 3
  s_waitcnt lgkmcnt(0)
  s_mov_b32 s16, s4
  s_and_b32 s17, s5, 0xffff
  s_mov_b32 s18, 2359296
  s_mov_b32 s19, 0x20000
  s_mov_b32 s20, s6
  s_and_b32 s21, s7, 0xffff
  s_mov_b32 s22, 1990656
  s_mov_b32 s23, 0x20000
  s_mov_b32 s24, s14
  s_and_b32 s25, s15, 0xffff
  s_mov_b32 s26, 16777216
  s_mov_b32 s27, 0x20000
  s_cmp_eq_u32 s67, 1
  s_cbranch_scc1 k1_prod0
  s_load_dwordx2 s[8:9], s[0:1], 16
  s_load_dwordx2 s[10:11], s[0:1], 32
  v_lshrrev_b32 v22, 3, v1
  v_lshrrev_b32 v23, 4, v1
  v_and_b32 v24, 7, v1
  v_xor_b32 v24, v24, v23
  v_mul_u32_u24 v22, 1152, v22
  v_lshl_add_u32 v4, v24, 4, v22
  v_xor_b32 v5, 64, v4
  v_and_b32 v25, 15, v1
  v_lshlrev_b32 v26, 2, v23
  v_xor_b32 v25, v25, v26
  v_mul_u32_u24 v26, 3456, v23
  v_lshl_add_u32 v6, v25, 4, v26
  s_lshl_b32 s46, s48, 1
  s_add_u32 s46, s46, 14
  v_cmp_gt_u32 s[60:61], s46, v25
  v_mov_b32 v26, 1073741824
  s_lshl_b32 s41, s36, 7
  s_lshl_b32 s46, s38, 5
  v_cndmask_b32 v6, v26, v6, s[60:61]
  s_add_u32 s41, s41, s46
  s_mul_i32 s41, s41, 1152
  s_mul_i32 s42, s38, 55296
  s_add_u32 s42, s42, s50
  s_lshl_b32 s43, s38, 12
  v_and_b32 v22, 3, v1
  s_lshl_b32 s46, s38, 2
  v_add_u32 v22, s46, v22
  v_lshrrev_b32 v23, 2, v1
  v_and_b32 v24, 3, v23
  v_lshlrev_b32 v24, 2, v24
  v_xor_b32 v22, v22, v24
  v_lshlrev_b32 v23, 8, v23
  v_lshl_add_u32 v20, v22, 4, v23
  v_add_u32 v20, 16384, v20
  s_mov_b32 s45, 0
  v_mov_b32 v40, 0
  v_mov_b32 v41, 0
  v_mov_b32 v42, 0
  v_mov_b32 v43, 0
  v_mov_b32 v44, 0
  v_mov_b32 v45, 0
  v_mov_b32 v46, 0
  v_mov_b32 v47, 0
  s_mov_b32 s44, 0
k1_lloop:
  s_cmp_lt_u32 s44, 3
  s_cbranch_scc1 k1_lskip
  s_waitcnt vmcnt(16)
  s_barrier
  v_add_u32 v21, s45, v20
  ds_read_b128 v[48:51], v21 offset:0
  ds_read_b128 v[52:55], v21 offset:4096
  ds_read_b128 v[56:59], v21 offset:8192
  ds_read_b128 v[60:63], v21 offset:12288
  s_add_u32 s45, s45, 32768
  s_and_b32 s45, s45, 0x1ffff
k1_lskip:
  s_add_u32 m0, s43, 0
  s_add_u32 s46, s41, 0
  buffer_load_dwordx4 v4, s[16:19], s46 offen lds
  s_add_u32 m0, s43, 16384
  s_add_u32 s46, s42, 0
  buffer_load_dwordx4 v6, s[20:23], s46 offen lds
  s_add_u32 m0, s43, 1024
  s_add_u32 s46, s41, 9216
  buffer_load_dwordx4 v5, s[16:19], s46 offen lds
  s_add_u32 m0, s43, 17408
  s_add_u32 s46, s42, 13824
  buffer_load_dwordx4 v6, s[20:23], s46 offen lds
  s_add_u32 m0, s43, 2048
  s_add_u32 s46, s41, 18432
  buffer_load_dwordx4 v4, s[16:19], s46 offen lds
  s_add_u32 m0, s43, 18432
  s_add_u32 s46, s42, 27648
  buffer_load_dwordx4 v6, s[20:23], s46 offen lds
  s_add_u32 m0, s43, 3072
  s_add_u32 s46, s41, 27648
  buffer_load_dwordx4 v5, s[16:19], s46 offen lds
  s_add_u32 m0, s43, 19456
  s_add_u32 s46, s42, 41472
  buffer_load_dwordx4 v6, s[20:23], s46 offen lds
  s_add_u32 s41, s41, 128
  s_add_u32 s42, s42, 221184
  s_add_u32 s43, s43, 32768
  s_and_b32 s43, s43, 0x1ffff
  s_cmp_lt_u32 s44, 3
  s_cbranch_scc1 k1_ncs
  s_getpc_b64 s[76:77]
k1_cb1:
  s_add_u32 s76, s76, k1_ncs-k1_cb1
  s_addc_u32 s77, s77, 0
  s_branch k1_csv
k1_ncs:
  s_add_u32 s44, s44, 1
  s_cmp_eq_u32 s44, 1
  s_cbranch_scc1 k1_wo
k1_cont:
  s_cmp_lt_u32 s44, 9
  s_cbranch_scc1 k1_lloop
  buffer_load_dwordx4 v[36:39], v12, s[56:59], 0 offen sc1
  s_waitcnt vmcnt(17)
  s_barrier
  s_getpc_b64 s[76:77]
k1_cb6:
  s_add_u32 s76, s76, k1_cr6-k1_cb6
  s_addc_u32 s77, s77, 0
  s_branch k1_csr
k1_cr6:
  s_waitcnt vmcnt(9)
  s_barrier
  s_getpc_b64 s[76:77]
k1_cb7:
  s_add_u32 s76, s76, k1_cr7-k1_cb7
  s_addc_u32 s77, s77, 0
  s_branch k1_csr
k1_cr7:
  s_mov_b32 s62, 0
  s_mov_b32 s74, 0
  s_waitcnt vmcnt(0)
  s_branch k1_pchk
k1_csr:
  v_add_u32 v21, s45, v20
  ds_read_b128 v[48:51], v21 offset:0
  ds_read_b128 v[52:55], v21 offset:4096
  ds_read_b128 v[56:59], v21 offset:8192
  ds_read_b128 v[60:63], v21 offset:12288
  s_add_u32 s45, s45, 32768
  s_and_b32 s45, s45, 0x1ffff
k1_csv:
  s_waitcnt lgkmcnt(3)
  v_lshlrev_b32 v64, 16, v48
  v_and_b32 v65, 0xffff0000, v48
  v_add_f32 v40, v40, v64
  v_add_f32 v41, v41, v65
  v_lshlrev_b32 v66, 16, v49
  v_and_b32 v67, 0xffff0000, v49
  v_add_f32 v42, v42, v66
  v_add_f32 v43, v43, v67
  v_lshlrev_b32 v68, 16, v50
  v_and_b32 v69, 0xffff0000, v50
  v_add_f32 v44, v44, v68
  v_add_f32 v45, v45, v69
  v_lshlrev_b32 v70, 16, v51
  v_and_b32 v71, 0xffff0000, v51
  v_add_f32 v46, v46, v70
  v_add_f32 v47, v47, v71
  s_waitcnt lgkmcnt(2)
  v_lshlrev_b32 v64, 16, v52
  v_and_b32 v65, 0xffff0000, v52
  v_add_f32 v40, v40, v64
  v_add_f32 v41, v41, v65
  v_lshlrev_b32 v66, 16, v53
  v_and_b32 v67, 0xffff0000, v53
  v_add_f32 v42, v42, v66
  v_add_f32 v43, v43, v67
  v_lshlrev_b32 v68, 16, v54
  v_and_b32 v69, 0xffff0000, v54
  v_add_f32 v44, v44, v68
  v_add_f32 v45, v45, v69
  v_lshlrev_b32 v70, 16, v55
  v_and_b32 v71, 0xffff0000, v55
  v_add_f32 v46, v46, v70
  v_add_f32 v47, v47, v71
  s_waitcnt lgkmcnt(1)
  v_lshlrev_b32 v64, 16, v56
  v_and_b32 v65, 0xffff0000, v56
  v_add_f32 v40, v40, v64
  v_add_f32 v41, v41, v65
  v_lshlrev_b32 v66, 16, v57
  v_and_b32 v67, 0xffff0000, v57
  v_add_f32 v42, v42, v66
  v_add_f32 v43, v43, v67
  v_lshlrev_b32 v68, 16, v58
  v_and_b32 v69, 0xffff0000, v58
  v_add_f32 v44, v44, v68
  v_add_f32 v45, v45, v69
  v_lshlrev_b32 v70, 16, v59
  v_and_b32 v71, 0xffff0000, v59
  v_add_f32 v46, v46, v70
  v_add_f32 v47, v47, v71
  s_waitcnt lgkmcnt(0)
  v_lshlrev_b32 v64, 16, v60
  v_and_b32 v65, 0xffff0000, v60
  v_add_f32 v40, v40, v64
  v_add_f32 v41, v41, v65
  v_lshlrev_b32 v66, 16, v61
  v_and_b32 v67, 0xffff0000, v61
  v_add_f32 v42, v42, v66
  v_add_f32 v43, v43, v67
  v_lshlrev_b32 v68, 16, v62
  v_and_b32 v69, 0xffff0000, v62
  v_add_f32 v44, v44, v68
  v_add_f32 v45, v45, v69
  v_lshlrev_b32 v70, 16, v63
  v_and_b32 v71, 0xffff0000, v63
  v_add_f32 v46, v46, v70
  v_add_f32 v47, v47, v71
  s_setpc_b64 s[76:77]
k1_poll:
  s_sleep 8
  buffer_load_dwordx4 v[36:39], v12, s[56:59], 0 offen sc1
  s_waitcnt vmcnt(0)
k1_pchk:
  v_and_b32 v36, v36, v37
  v_and_b32 v38, v38, v39
  v_and_b32 v36, v36, v38
  s_nop 0
  v_readfirstlane_b32 s63, v36
  s_add_u32 s62, s62, 1
  s_cmp_eq_u32 s63, 0x01010101
  s_cbranch_scc1 k1_polled
  s_cmp_lt_u32 s62, 64
  s_cbranch_scc1 k1_poll
  s_mov_b32 s64, 0
  s_mov_b32 s73, 1
  s_mov_b32 s74, 1
  s_branch k1_prod
k1_polled:
  s_lshl_b32 s46, s36, 10
  s_lshl_b32 s62, s38, 8
  s_add_u32 s46, s46, s62
  s_add_u32 s46, s46, 15269888
  v_lshlrev_b32 v22, 3, v2
  buffer_load_dwordx2 v[32:33], v22, s[24:27], s46 offen sc1
  s_barrier
  s_getpc_b64 s[76:77]
k1_cb8:
  s_add_u32 s76, s76, k1_cr8-k1_cb8
  s_addc_u32 s77, s77, 0
  s_branch k1_csr
k1_cr8:
  v_mov_b32 v72, v40
  v_mov_b32 v73, v41
  v_mov_b32 v74, v42
  v_mov_b32 v75, v43
  v_mov_b32 v76, v44
  v_mov_b32 v77, v45
  v_mov_b32 v78, v46
  v_mov_b32 v79, v47
  v_permlane32_swap_b32 v40, v72
  v_permlane32_swap_b32 v41, v73
  v_permlane32_swap_b32 v42, v74
  v_permlane32_swap_b32 v43, v75
  v_permlane32_swap_b32 v44, v76
  v_permlane32_swap_b32 v45, v77
  v_permlane32_swap_b32 v46, v78
  v_permlane32_swap_b32 v47, v79
  v_add_f32 v40, v40, v72
  v_add_f32 v41, v41, v73
  v_add_f32 v42, v42, v74
  v_add_f32 v43, v43, v75
  v_add_f32 v44, v44, v76
  v_add_f32 v45, v45, v77
  v_add_f32 v46, v46, v78
  v_add_f32 v47, v47, v79
  v_mov_b32 v72, v40
  v_mov_b32 v73, v41
  v_mov_b32 v74, v42
  v_mov_b32 v75, v43
  v_mov_b32 v76, v44
  v_mov_b32 v77, v45
  v_mov_b32 v78, v46
  v_mov_b32 v79, v47
  v_permlane16_swap_b32 v40, v72
  v_permlane16_swap_b32 v41, v73
  v_permlane16_swap_b32 v42, v74
  v_permlane16_swap_b32 v43, v75
  v_permlane16_swap_b32 v44, v76
  v_permlane16_swap_b32 v45, v77
  v_permlane16_swap_b32 v46, v78
  v_permlane16_swap_b32 v47, v79
  v_add_f32 v40, v40, v72
  v_add_f32 v41, v41, v73
  v_add_f32 v42, v42, v74
  v_add_f32 v43, v43, v75
  v_add_f32 v44, v44, v76
  v_add_f32 v45, v45, v77
  v_add_f32 v46, v46, v78
  v_add_f32 v47, v47, v79
  v_add_f32_dpp v40, v40, v40 row_ror:4 row_mask:0xf bank_mask:0xf
  v_add_f32_dpp v41, v41, v41 row_ror:4 row_mask:0xf bank_mask:0xf
  v_add_f32_dpp v42, v42, v42 row_ror:4 row_mask:0xf bank_mask:0xf
  v_add_f32_dpp v43, v43, v43 row_ror:4 row_mask:0xf bank_mask:0xf
  v_add_f32_dpp v44, v44, v44 row_ror:4 row_mask:0xf bank_mask:0xf
  v_add_f32_dpp v45, v45, v45 row_ror:4 row_mask:0xf bank_mask:0xf
  v_add_f32_dpp v46, v46, v46 row_ror:4 row_mask:0xf bank_mask:0xf
  v_add_f32_dpp v47, v47, v47 row_ror:4 row_mask:0xf bank_mask:0xf
  v_add_f32_dpp v40, v40, v40 row_ror:8 row_mask:0xf bank_mask:0xf
  v_add_f32_dpp v41, v41, v41 row_ror:8 row_mask:0xf bank_mask:0xf
  v_add_f32_dpp v42, v42, v42 row_ror:8 row_mask:0xf bank_mask:0xf
  v_add_f32_dpp v43, v43, v43 row_ror:8 row_mask:0xf bank_mask:0xf
  v_add_f32_dpp v44, v44, v44 row_ror:8 row_mask:0xf bank_mask:0xf
  v_add_f32_dpp v45, v45, v45 row_ror:8 row_mask:0xf bank_mask:0xf
  v_add_f32_dpp v46, v46, v46 row_ror:8 row_mask:0xf bank_mask:0xf
  v_add_f32_dpp v47, v47, v47 row_ror:8 row_mask:0xf bank_mask:0xf
  v_and_b32 v28, 3, v1
  s_lshl_b32 s63, s38, 7
  v_lshl_add_u32 v28, v28, 5, s63
  ds_write_b128 v28, v[40:43] offset:33792
  ds_write_b128 v28, v[44:47] offset:33808
  s_cmp_eq_u32 s74, 0
  s_cbranch_scc1 k1_fetched
  buffer_load_dwordx2 v[32:33], v22, s[24:27], s46 offen sc1
k1_fetched:
  v_add_u32 v22, s62, v22
  s_waitcnt vmcnt(0)
  ds_write_b64 v22, v[32:33] offset:32768
  s_waitcnt lgkmcnt(0)
  s_barrier
  s_branch k1_side
k1_wo:
  s_lshl_b32 s46, s36, 4
  v_mov_b32 v12, s46
  s_waitcnt lgkmcnt(0)
  s_mov_b32 s28, s8
  s_and_b32 s29, s9, 0xffff
  s_mov_b32 s30, 663552
  s_mov_b32 s31, 0x20000
  s_mov_b32 s32, s10
  s_and_b32 s33, s11, 0xffff
  s_mov_b32 s34, 1152
  s_mov_b32 s35, 0x20000
  s_mov_b32 s56, s12
  s_and_b32 s57, s13, 0xffff
  s_mov_b32 s58, 256
  s_mov_b32 s59, 0x20000
  s_lshl_b32 s51, s38, 8
  s_add_u32 s51, s51, s2
  s_mul_i32 s68, s51, 1821
  s_lshr_b32 s68, s68, 16
  s_mul_i32 s69, s68, 36
  s_sub_u32 s69, s51, s69
  s_mul_i32 s70, s69, 20736
  s_sub_u32 s46, s69, 32
  s_mul_i32 s46, s46, 165888
  s_add_u32 s46, s46, 18432
  s_cmp_ge_u32 s69, 32
  s_cselect_b32 s70, s46, s70
  s_mov_b32 s71, 9216
  s_cselect_b32 s71, 82944, s71
  s_mov_b32 s72, 2304
  s_cselect_b32 s72, 20736, s72
  s_cmp_ge_u32 s51, 648
  s_cselect_b32 s70, 1073741824, s70
  v_and_b32 v22, 0x13, v2
  v_and_b32 v23, 4, v2
  v_lshl_or_b32 v22, v23, 1, v22
  v_and_b32 v23, 8, v2
  v_lshrrev_b32 v23, 1, v23
  v_or_b32 v22, v22, v23
  s_lshl_b32 s68, s68, 5
  v_add_u32 v22, s68, v22
  v_lshlrev_b32 v22, 1, v22
  v_mul_lo_u32 v23, v3, s71
  v_add_u32 v22, v22, v23
  buffer_load_ushort v16, v22, s[28:31], s70 offen
  buffer_load_ushort v8, v22, s[28:31], s70 offen offset:1152
  s_add_u32 s70, s70, s72
  buffer_load_ushort v17, v22, s[28:31], s70 offen
  buffer_load_ushort v9, v22, s[28:31], s70 offen offset:1152
  s_add_u32 s70, s70, s72
  buffer_load_ushort v18, v22, s[28:31], s70 offen
  buffer_load_ushort v10, v22, s[28:31], s70 offen offset:1152
  s_add_u32 s70, s70, s72
  buffer_load_ushort v19, v22, s[28:31], s70 offen
  buffer_load_ushort v11, v22, s[28:31], s70 offen offset:1152
  s_branch k1_cont
k1_prod0:
  s_mov_b32 s64, s37
  s_mov_b32 s73, 0
k1_prod:
  v_mul_u32_u24 v32, 1152, v3
  v_lshl_add_u32 v32, v2, 4, v32
  v_cmp_gt_u32 s[60:61], 8, v2
  v_mov_b32 v26, 1073741824
  s_nop 0
  v_cndmask_b32 v33, v26, v32, s[60:61]
k1_ploop:
  s_lshl_b32 s46, s36, 7
  s_lshl_b32 s68, s64, 3
  s_add_u32 s46, s46, s68
  s_lshl_b32 s68, s38, 1
  s_add_u32 s68, s46, s68
  s_mul_i32 s46, s68, 1152
  buffer_load_dwordx4 v[176:179], v32, s[16:19], s46 offen
  buffer_load_dwordx4 v[180:183], v32, s[16:19], s46 offen offset:512
  buffer_load_dwordx4 v[184:187], v33, s[16:19], s46 offen offset:1024
  s_cmp_eq_u32 s73, 0
  s_cbranch_scc1 k1_compute
k1_pfin:
  v_mov_b32 v188, 0
  v_mov_b32 v189, 0
  v_mov_b32 v190, 0
  v_mov_b32 v191, 0
  s_waitcnt vmcnt(2)
  v_lshlrev_b32 v192, 16, v176
  v_and_b32 v193, 0xffff0000, v176
  v_add_f32 v188, v188, v192
  v_add_f32 v189, v189, v193
  v_fmac_f32 v190, v192, v192
  v_fmac_f32 v191, v193, v193
  v_lshlrev_b32 v194, 16, v177
  v_and_b32 v195, 0xffff0000, v177
  v_add_f32 v188, v188, v194
  v_add_f32 v189, v189, v195
  v_fmac_f32 v190, v194, v194
  v_fmac_f32 v191, v195, v195
  v_lshlrev_b32 v196, 16, v178
  v_and_b32 v197, 0xffff0000, v178
  v_add_f32 v188, v188, v196
  v_add_f32 v189, v189, v197
  v_fmac_f32 v190, v196, v196
  v_fmac_f32 v191, v197, v197
  v_lshlrev_b32 v198, 16, v179
  v_and_b32 v199, 0xffff0000, v179
  v_add_f32 v188, v188, v198
  v_add_f32 v189, v189, v199
  v_fmac_f32 v190, v198, v198
  v_fmac_f32 v191, v199, v199
  s_waitcnt vmcnt(1)
  v_lshlrev_b32 v192, 16, v180
  v_and_b32 v193, 0xffff0000, v180
  v_add_f32 v188, v188, v192
  v_add_f32 v189, v189, v193
  v_fmac_f32 v190, v192, v192
  v_fmac_f32 v191, v193, v193
  v_lshlrev_b32 v194, 16, v181
  v_and_b32 v195, 0xffff0000, v181
  v_add_f32 v188, v188, v194
  v_add_f32 v189, v189, v195
  v_fmac_f32 v190, v194, v194
  v_fmac_f32 v191, v195, v195
  v_lshlrev_b32 v196, 16, v182
  v_and_b32 v197, 0xffff0000, v182
  v_add_f32 v188, v188, v196
  v_add_f32 v189, v189, v197
  v_fmac_f32 v190, v196, v196
  v_fmac_f32 v191, v197, v197
  v_lshlrev_b32 v198, 16, v183
  v_and_b32 v199, 0xffff0000, v183
  v_add_f32 v188, v188, v198
  v_add_f32 v189, v189, v199
  v_fmac_f32 v190, v198, v198
  v_fmac_f32 v191, v199, v199
  s_waitcnt vmcnt(0)
  v_lshlrev_b32 v192, 16, v184
  v_and_b32 v193, 0xffff0000, v184
  v_add_f32 v188, v188, v192
  v_add_f32 v189, v189, v193
  v_fmac_f32 v190, v192, v192
  v_fmac_f32 v191, v193, v193
  v_lshlrev_b32 v194, 16, v185
  v_and_b32 v195, 0xffff0000, v185
  v_add_f32 v188, v188, v194
  v_add_f32 v189, v189, v195
  v_fmac_f32 v190, v194, v194
  v_fmac_f32 v191, v195, v195
  v_lshlrev_b32 v196, 16, v186
  v_and_b32 v197, 0xffff0000, v186
  v_add_f32 v188, v188, v196
  v_add_f32 v189, v189, v197
  v_fmac_f32 v190, v196, v196
  v_fmac_f32 v191, v197, v197
  v_lshlrev_b32 v198, 16, v187
  v_and_b32 v199, 0xffff0000, v187
  v_add_f32 v188, v188, v198
  v_add_f32 v189, v189, v199
  v_fmac_f32 v190, v198, v198
  v_fmac_f32 v191, v199, v199
  v_add_f32 v188, v188, v189
  v_add_f32 v190, v190, v191
  s_lshl_b32 s46, s68, 3
  s_add_u32 s46, s46, 15269888
  v_add_f32_dpp v188, v188, v188 row_shr:1 row_mask:0xf bank_mask:0xf
  v_add_f32_dpp v190, v190, v190 row_shr:1 row_mask:0xf bank_mask:0xf
  s_nop 0
  v_add_f32_dpp v188, v188, v188 row_shr:2 row_mask:0xf bank_mask:0xf
  v_add_f32_dpp v190, v190, v190 row_shr:2 row_mask:0xf bank_mask:0xf
  s_nop 0
  v_add_f32_dpp v188, v188, v188 row_shr:4 row_mask:0xf bank_mask:0xf
  v_add_f32_dpp v190, v190, v190 row_shr:4 row_mask:0xf bank_mask:0xf
  s_nop 0
  v_add_f32_dpp v188, v188, v188 row_shr:8 row_mask:0xf bank_mask:0xf
  v_add_f32_dpp v190, v190, v190 row_shr:8 row_mask:0xf bank_mask:0xf
  s_nop 0
  v_add_f32_dpp v188, v188, v188 row_bcast:15 row_mask:0xa bank_mask:0xf
  v_add_f32_dpp v190, v190, v190 row_bcast:15 row_mask:0xa bank_mask:0xf
  s_nop 0
  v_mul_f32 v24, 0x3ae38e39, v188
  v_mul_f32 v25, 0x3ae38e39, v190
  v_fma_f32 v25, -v24, v24, v25
  v_max_f32 v25, 0, v25
  v_cvt_pk_bf16_f32 v24, v24, v24
  v_cvt_pk_bf16_f32 v25, v25, v25
  v_and_b32 v24, 0xffff0000, v24
  v_and_b32 v25, 0xffff0000, v25
  v_add_f32 v25, 0x3727c5ac, v25
  v_cvt_pk_bf16_f32 v25, v25, v25
  v_and_b32 v25, 0xffff0000, v25
  v_sqrt_f32 v25, v25
  v_sub_f32 v23, 0, v24
  v_cvt_pk_bf16_f32 v25, v25, v25
  v_and_b32 v25, 0xffff0000, v25
  v_rcp_f32 v22, v25
  v_lshlrev_b32 v24, 3, v3
  s_mov_b32 exec_lo, 0x80000000
  s_mov_b32 exec_hi, 0x80000000
  buffer_store_dwordx2 v[22:23], v24, s[24:27], s46 offen sc1
  s_mov_b64 exec, -1
  s_cmp_eq_u32 s73, 0
  s_cbranch_scc1 k1_pret
  s_add_u32 s64, s64, 1
  s_waitcnt vmcnt(0)
  s_cmp_lt_u32 s64, 16
  s_cbranch_scc1 k1_ploop
  s_branch k1_polled
k1_side:
  s_lshl_b32 s46, s51, 10
  s_add_u32 s46, s46, 11010048
  s_cmp_ge_u32 s51, 648
  s_cselect_b32 s46, 1073741824, s46
  v_lshlrev_b32 v22, 4, v1
  v_lshl_or_b32 v16, v8, 16, v16
  v_lshl_or_b32 v17, v9, 16, v17
  v_lshl_or_b32 v18, v10, 16, v18
  v_lshl_or_b32 v19, v11, 16, v19
  buffer_store_dwordx4 v[16:19], v22, s[24:27], s46 offen
  s_cmp_lt_u32 s2, 240
  s_cbranch_scc1 k1_end
  s_add_u32 s52, s14, 15204352
  s_addc_u32 s53, s15, 0
  s_and_b32 s53, s53, 0xffff
  s_mov_b32 s54, 51904
  s_mov_b32 s55, 0x20000
  s_sub_u32 s46, s2, 240
  s_lshl_b32 s46, s46, 12
  v_lshlrev_b32 v23, 4, v0
  v_mov_b32 v32, 0
  v_mov_b32 v33, 0
  v_mov_b32 v34, 0
  v_mov_b32 v35, 0
  buffer_store_dwordx4 v[32:35], v23, s[52:55], s46 offen
  s_cmp_lg_u32 s51, 1023
  s_cbranch_scc1 k1_end
  v_lshlrev_b32 v23, 2, v1
  buffer_load_dword v36, v23, s[32:35], 0 offen offset:0
  buffer_load_dword v37, v23, s[32:35], 0 offen offset:256
  buffer_load_dword v38, v23, s[32:35], 0 offen offset:512
  buffer_load_dword v39, v23, s[32:35], 0 offen offset:768
  buffer_load_dword v40, v23, s[32:35], 0 offen offset:1024
  v_mov_b32 v24, 0
  s_waitcnt vmcnt(0)
  v_dot2_f32_bf16 v24, v36, s47, v24
  v_dot2_f32_bf16 v24, v37, s47, v24
  v_dot2_f32_bf16 v24, v38, s47, v24
  v_dot2_f32_bf16 v24, v39, s47, v24
  v_dot2_f32_bf16 v24, v40, s47, v24
  s_nop 3
  v_mov_b32 v25, 0
  s_nop 1
  v_mov_b32_dpp v25, v24 row_shr:1 row_mask:0xf bank_mask:0xf
  v_add_f32 v24, v24, v25
  v_mov_b32 v25, 0
  s_nop 1
  v_mov_b32_dpp v25, v24 row_shr:2 row_mask:0xf bank_mask:0xf
  v_add_f32 v24, v24, v25
  v_mov_b32 v25, 0
  s_nop 1
  v_mov_b32_dpp v25, v24 row_shr:4 row_mask:0xf bank_mask:0xf
  v_add_f32 v24, v24, v25
  v_mov_b32 v25, 0
  s_nop 1
  v_mov_b32_dpp v25, v24 row_shr:8 row_mask:0xf bank_mask:0xf
  v_add_f32 v24, v24, v25
  v_mov_b32 v25, 0
  s_nop 1
  v_mov_b32_dpp v25, v24 row_bcast:15 row_mask:0xa bank_mask:0xf
  v_add_f32 v24, v24, v25
  v_mov_b32 v25, 0
  s_nop 1
  v_mov_b32_dpp v25, v24 row_bcast:31 row_mask:0xc bank_mask:0xf
  v_add_f32 v24, v24, v25
  v_mov_b32 v23, 15257600
  s_mov_b32 exec_lo, 0
  s_mov_b32 exec_hi, 0x80000000
  buffer_store_dword v24, v23, s[24:27], 0 offen
  s_endpgm
k1_compute:
  s_lshr_b32 s39, s38, 1
  s_and_b32 s40, s38, 1
  s_mov_b32 s49, 0xffff0000
  v_bfe_u32 v22, v2, 1, 3
  v_xor_b32 v22, v22, v3
  v_lshlrev_b32 v23, 7, v2
  v_lshl_add_u32 v23, v22, 4, v23
  s_lshl_b32 s46, s38, 12
  v_add_u32 v7, s46, v23
  v_xor_b32 v8, 4096, v7
  v_bfe_u32 v22, v1, 2, 2
  v_and_b32 v23, 3, v1
  v_bfe_u32 v24, v1, 4, 1
  v_lshl_add_u32 v25, v3, 3, v22
  v_lshl_add_u32 v26, v24, 2, v23
  v_and_b32 v27, 1, v23
  v_lshlrev_b32 v27, 1, v27
  v_lshrrev_b32 v28, 1, v23
  v_or_b32 v27, v27, v28
  v_mad_u32_u24 v27, v24, 5, v27
  s_lshl_b32 s61, s40, 1
  s_add_u32 s62, s61, 1
  s_add_u32 s61, s61, s39
  s_sub_u32 s62, s62, s39
  s_mul_i32 s46, s61, 72
  v_lshl_add_u32 v28, v27, 3, s46
  v_min_u32 v29, 2, v26
  v_mul_u32_u24 v29, 72, v29
  v_add_u32 v29, 32, v29
  s_cmp_eq_u32 s61, 3
  s_cselect_b64 vcc, -1, 0
  s_lshl_b32 s46, s61, 6
  v_lshl_add_u32 v30, v26, 3, s46
  v_cndmask_b32 v28, v28, v29, vcc
  s_cmp_eq_u32 s48, 1
  s_cselect_b64 vcc, -1, 0
  s_nop 1
  v_cndmask_b32 v28, v28, v30, vcc
  v_lshrrev_b32 v29, 4, v28
  v_lshlrev_b32 v30, 2, v22
  v_xor_b32 v29, v29, v30
  v_and_b32 v28, 15, v28
  v_lshl_add_u32 v28, v29, 4, v28
  v_lshl_add_u32 v28, v25, 8, v28
  v_add_u32 v9, 16384, v28
  s_mul_i32 s46, s62, 72
  v_lshl_add_u32 v28, v27, 3, s46
  v_min_u32 v29, 2, v26
  v_mul_u32_u24 v29, 72, v29
  v_add_u32 v29, 32, v29
  s_cmp_eq_u32 s62, 3
  s_cselect_b64 vcc, -1, 0
  s_lshl_b32 s46, s62, 6
  v_lshl_add_u32 v30, v26, 3, s46
  v_cndmask_b32 v28, v28, v29, vcc
  s_cmp_eq_u32 s48, 1
  s_cselect_b64 vcc, -1, 0
  s_nop 1
  v_cndmask_b32 v28, v28, v30, vcc
  v_lshrrev_b32 v29, 4, v28
  v_lshlrev_b32 v30, 2, v22
  v_xor_b32 v29, v29, v30
  v_and_b32 v28, 15, v28
  v_lshl_add_u32 v28, v29, 4, v28
  v_lshl_add_u32 v28, v25, 8, v28
  v_add_u32 v10, 16384, v28
  v_mov_b32 v64, 0
  v_mov_b32 v65, 0
  v_mov_b32 v66, 0
  v_mov_b32 v67, 0
  v_mov_b32 v68, 0
  v_mov_b32 v69, 0
  v_mov_b32 v70, 0
  v_mov_b32 v71, 0
  v_mov_b32 v72, 0
  v_mov_b32 v73, 0
  v_mov_b32 v74, 0
  v_mov_b32 v75, 0
  v_mov_b32 v76, 0
  v_mov_b32 v77, 0
  v_mov_b32 v78, 0
  v_mov_b32 v79, 0
  v_mov_b32 v80, 0
  v_mov_b32 v81, 0
  v_mov_b32 v82, 0
  v_mov_b32 v83, 0
  v_mov_b32 v84, 0
  v_mov_b32 v85, 0
  v_mov_b32 v86, 0
  v_mov_b32 v87, 0
  v_mov_b32 v88, 0
  v_mov_b32 v89, 0
  v_mov_b32 v90, 0
  v_mov_b32 v91, 0
  v_mov_b32 v92, 0
  v_mov_b32 v93, 0
  v_mov_b32 v94, 0
  v_mov_b32 v95, 0
  v_mov_b32 v96, 0
  v_mov_b32 v97, 0
  v_mov_b32 v98, 0
  v_mov_b32 v99, 0
  v_mov_b32 v100, 0
  v_mov_b32 v101, 0
  v_mov_b32 v102, 0
  v_mov_b32 v103, 0
  v_mov_b32 v104, 0
  v_mov_b32 v105, 0
  v_mov_b32 v106, 0
  v_mov_b32 v107, 0
  v_mov_b32 v108, 0
  v_mov_b32 v109, 0
  v_mov_b32 v110, 0
  v_mov_b32 v111, 0
  v_mov_b32 v112, 0
  v_mov_b32 v113, 0
  v_mov_b32 v114, 0
  v_mov_b32 v115, 0
  v_mov_b32 v116, 0
  v_mov_b32 v117, 0
  v_mov_b32 v118, 0
  v_mov_b32 v119, 0
  v_mov_b32 v120, 0
  v_mov_b32 v121, 0
  v_mov_b32 v122, 0
  v_mov_b32 v123, 0
  v_mov_b32 v124, 0
  v_mov_b32 v125, 0
  v_mov_b32 v126, 0
  v_mov_b32 v127, 0
  v_mov_b32 v128, 0
  v_mov_b32 v129, 0
  v_mov_b32 v130, 0
  v_mov_b32 v131, 0
  v_mov_b32 v132, 0
  v_mov_b32 v133, 0
  v_mov_b32 v134, 0
  v_mov_b32 v135, 0
  v_mov_b32 v136, 0
  v_mov_b32 v137, 0
  v_mov_b32 v138, 0
  v_mov_b32 v139, 0
  v_mov_b32 v140, 0
  v_mov_b32 v141, 0
  v_mov_b32 v142, 0
  v_mov_b32 v143, 0
  v_mov_b32 v144, 0
  v_mov_b32 v145, 0
  v_mov_b32 v146, 0
  v_mov_b32 v147, 0
  v_mov_b32 v148, 0
  v_mov_b32 v149, 0
  v_mov_b32 v150, 0
  v_mov_b32 v151, 0
  v_mov_b32 v152, 0
  v_mov_b32 v153, 0
  v_mov_b32 v154, 0
  v_mov_b32 v155, 0
  v_mov_b32 v156, 0
  v_mov_b32 v157, 0
  v_mov_b32 v158, 0
  v_mov_b32 v159, 0
  v_mov_b32 v160, 0
  v_mov_b32 v161, 0
  v_mov_b32 v162, 0
  v_mov_b32 v163, 0
  v_mov_b32 v164, 0
  v_mov_b32 v165, 0
  v_mov_b32 v166, 0
  v_mov_b32 v167, 0
  v_mov_b32 v168, 0
  v_mov_b32 v169, 0
  v_mov_b32 v170, 0
  v_mov_b32 v171, 0
  v_mov_b32 v172, 0
  v_mov_b32 v173, 0
  v_mov_b32 v174, 0
  v_mov_b32 v175, 0
  v_mov_b32 v28, s47
  v_mov_b32 v29, s47
  v_mov_b32 v30, s47
  v_mov_b32 v31, s47
  s_mov_b32 s44, 0
  s_mov_b32 s45, 0
  s_lshl_b32 s46, s36, 4
  s_add_u32 s46, s46, s37
  v_mov_b32 v18, s46
  v_mov_b32 v19, 1
  s_mov_b32 s56, s12
  s_and_b32 s57, s13, 0xffff
  s_mov_b32 s58, 256
  s_mov_b32 s59, 0x20000
  s_branch k1_go
k1_pret:
  s_cmp_eq_u32 s48, 1
  s_cbranch_scc1 k1_retV
  s_branch k1_retQ
k1_go:
  s_cmp_eq_u32 s48, 1
  s_cbranch_scc1 k1_vpath
.p2align 3
k1_kernel_loop1:
  s_barrier
  v_add_u32 v11, s45, v7
  v_add_u32 v12, s45, v8
  v_add_u32 v13, s45, v9
  v_add_u32 v14, s45, v10
  ds_read_b128 v[32:35], v11
  ds_read_b128 v[36:39], v12
  ds_read_b64_tr_b16 v[40:41], v13 offset:0
  ds_read_b64_tr_b16 v[42:43], v13 offset:1024
  ds_read_b64_tr_b16 v[44:45], v14 offset:0
  ds_read_b64_tr_b16 v[46:47], v14 offset:1024
  v_xor_b32 v4, 32, v11
  v_xor_b32 v5, 64, v11
  v_xor_b32 v6, 96, v11
  v_xor_b32 v15, 32, v12
  v_xor_b32 v16, 64, v12
  v_xor_b32 v17, 96, v12
  s_cmp_eq_u32 s44, 0
  s_cbranch_scc1 k1_pfin
k1_retQ:
  v_mfma_f32_32x32x16_bf16 v[96:111], v[72:75], v[64:67], v[96:111]
  v_mfma_f32_32x32x16_bf16 v[112:127], v[76:79], v[64:67], v[112:127]
  v_mfma_f32_32x32x16_bf16 v[128:143], v[72:75], v[68:71], v[128:143]
  v_mfma_f32_32x32x16_bf16 v[144:159], v[76:79], v[68:71], v[144:159]
  ds_read_b128 v[48:51], v4
  ds_read_b128 v[52:55], v15
  ds_read_b64_tr_b16 v[56:57], v13 offset:4096
  ds_read_b64_tr_b16 v[58:59], v13 offset:5120
  ds_read_b64_tr_b16 v[60:61], v14 offset:4096
  ds_read_b64_tr_b16 v[62:63], v14 offset:5120
  v_mfma_f32_32x32x16_bf16 v[96:111], v[88:91], v[80:83], v[96:111]
  v_mfma_f32_32x32x16_bf16 v[112:127], v[92:95], v[80:83], v[112:127]
  v_mfma_f32_32x32x16_bf16 v[128:143], v[88:91], v[84:87], v[128:143]
  v_mfma_f32_32x32x16_bf16 v[144:159], v[92:95], v[84:87], v[144:159]
  ds_read_b128 v[64:67], v5
  ds_read_b128 v[68:71], v16
  ds_read_b64_tr_b16 v[72:73], v13 offset:8192
  ds_read_b64_tr_b16 v[74:75], v13 offset:9216
  ds_read_b64_tr_b16 v[76:77], v14 offset:8192
  ds_read_b64_tr_b16 v[78:79], v14 offset:9216
  s_cmp_lg_u32 s44, 2
  s_cbranch_scc1 k1_kernel_loop1z
  s_cmp_lg_u32 s38, 0
  s_cbranch_scc1 k1_kernel_loop1z
  s_mov_b64 exec, 1
  buffer_store_byte v19, v18, s[56:59], 0 offen sc1
  s_mov_b64 exec, -1
k1_kernel_loop1z:
  s_waitcnt lgkmcnt(12)
  v_mfma_f32_32x32x16_bf16 v[96:111], v[40:43], v[32:35], v[96:111]
  v_mfma_f32_32x32x16_bf16 v[112:127], v[44:47], v[32:35], v[112:127]
  v_mfma_f32_32x32x16_bf16 v[128:143], v[40:43], v[36:39], v[128:143]
  v_mfma_f32_32x32x16_bf16 v[144:159], v[44:47], v[36:39], v[144:159]
  ds_read_b128 v[80:83], v6
  ds_read_b128 v[84:87], v17
  ds_read_b64_tr_b16 v[88:89], v13 offset:12288
  ds_read_b64_tr_b16 v[90:91], v13 offset:13312
  ds_read_b64_tr_b16 v[92:93], v14 offset:12288
  ds_read_b64_tr_b16 v[94:95], v14 offset:13312
  s_waitcnt lgkmcnt(12)
  v_mfma_f32_32x32x16_bf16 v[96:111], v[56:59], v[48:51], v[96:111]
  v_mfma_f32_32x32x16_bf16 v[112:127], v[60:63], v[48:51], v[112:127]
  v_mfma_f32_32x32x16_bf16 v[128:143], v[56:59], v[52:55], v[128:143]
  v_mfma_f32_32x32x16_bf16 v[144:159], v[60:63], v[52:55], v[144:159]
  s_add_u32 s45, s45, 32768
  s_and_b32 s45, s45, 0x1ffff
  s_add_u32 s44, s44, 1
  s_cmp_lg_u32 s44, 2
  s_cbranch_scc1 k1_kernel_loop1y
  s_waitcnt vmcnt(0)
k1_kernel_loop1y:
  s_cmp_lt_u32 s44, 9
  s_waitcnt lgkmcnt(0)
  s_cbranch_scc1 k1_kernel_loop1
  v_mfma_f32_32x32x16_bf16 v[96:111], v[72:75], v[64:67], v[96:111]
  v_mfma_f32_32x32x16_bf16 v[112:127], v[76:79], v[64:67], v[112:127]
  v_mfma_f32_32x32x16_bf16 v[128:143], v[72:75], v[68:71], v[128:143]
  v_mfma_f32_32x32x16_bf16 v[144:159], v[76:79], v[68:71], v[144:159]
  v_mfma_f32_32x32x16_bf16 v[96:111], v[88:91], v[80:83], v[96:111]
  v_mfma_f32_32x32x16_bf16 v[112:127], v[92:95], v[80:83], v[112:127]
  v_mfma_f32_32x32x16_bf16 v[128:143], v[88:91], v[84:87], v[128:143]
  v_mfma_f32_32x32x16_bf16 v[144:159], v[92:95], v[84:87], v[144:159]
  s_barrier
  s_lshl_b32 s46, s38, 8
  v_lshl_add_u32 v26, v2, 3, s46
  v_xor_b32 v27, 256, v26
  ds_read_b64 v[22:23], v26 offset:32768
  ds_read_b64 v[24:25], v27 offset:32768
  s_mul_i32 s46, s61, 144
  s_cmp_eq_u32 s61, 3
  s_cselect_b32 s46, 64, s46
  s_cselect_b32 s66, 144, 32
  s_cselect_b32 s67, 272, 0
  v_mul_lo_u32 v26, v3, s66
  v_add_u32 v26, s46, v26
  v_add_u32 v27, s67, v26
  ds_read_b128 v[160:163], v26 offset:33792
  ds_read_b128 v[164:167], v27 offset:33808
  ds_read_b128 v[168:171], v26 offset:33872
  ds_read_b128 v[172:175], v26 offset:33888
  s_mul_i32 s46, s62, 144
  s_cmp_eq_u32 s62, 3
  s_cselect_b32 s46, 64, s46
  s_cselect_b32 s66, 144, 32
  s_cselect_b32 s67, 272, 0
  v_mul_lo_u32 v26, v3, s66
  v_add_u32 v26, s46, v26
  v_add_u32 v27, s67, v26
  ds_read_b128 v[176:179], v26 offset:33792
  ds_read_b128 v[180:183], v27 offset:33808
  ds_read_b128 v[184:187], v26 offset:33872
  ds_read_b128 v[188:191], v26 offset:33888
  v_lshlrev_b32 v29, 4, v1
  s_lshl_b32 s63, s36, 2
  s_xor_b32 s64, s38, 1
  s_add_u32 s64, s64, s63
  s_add_u32 s63, s63, s38
  s_mul_i32 s65, s37, 3
  s_waitcnt lgkmcnt(0)
  s_cmp_eq_u32 s61, 3
  s_cbranch_scc1 k1_kernel_rem2
  s_add_u32 s66, s65, s61
  s_cmp_ge_u32 s66, 32
  s_cbranch_scc1 k1_kernel_next3
  s_and_b32 s67, s66, 15
  s_lshl_b32 s67, s67, 1
  s_cmp_lt_u32 s66, 16
  s_cselect_b32 s68, 0x3eae1a93, 1.0
  s_mov_b32 s69, 151552
  s_cselect_b32 s69, 65536, s69
  s_lshr_b32 s70, s63, 1
  s_mul_i32 s70, s70, 4736
  s_and_b32 s71, s63, 1
  s_lshl_b32 s71, s71, 10
  s_add_u32 s70, s70, s71
  s_lshl_b32 s71, s63, 10
  s_add_u32 s71, s71, 5242880
  s_cmp_lt_u32 s66, 16
  s_cselect_b32 s70, s71, s70
  s_mul_i32 s71, s67, s69
  s_add_u32 s70, s70, s71
  s_add_u32 s71, s70, s69
  v_mul_f32 v32, s68, v22
  v_pk_fma_f32 v[96:97], v[160:161], v[22:23], v[96:97] op_sel:[0,1,0] op_sel_hi:[1,1,1]
  v_pk_fma_f32 v[98:99], v[162:163], v[22:23], v[98:99] op_sel:[0,1,0] op_sel_hi:[1,1,1]
  v_pk_fma_f32 v[100:101], v[164:165], v[22:23], v[100:101] op_sel:[0,1,0] op_sel_hi:[1,1,1]
  v_pk_fma_f32 v[102:103], v[166:167], v[22:23], v[102:103] op_sel:[0,1,0] op_sel_hi:[1,1,1]
  v_pk_fma_f32 v[104:105], v[168:169], v[22:23], v[104:105] op_sel:[0,1,0] op_sel_hi:[1,1,1]
  v_pk_fma_f32 v[106:107], v[170:171], v[22:23], v[106:107] op_sel:[0,1,0] op_sel_hi:[1,1,1]
  v_pk_fma_f32 v[108:109], v[172:173], v[22:23], v[108:109] op_sel:[0,1,0] op_sel_hi:[1,1,1]
  v_pk_fma_f32 v[110:111], v[174:175], v[22:23], v[110:111] op_sel:[0,1,0] op_sel_hi:[1,1,1]
  v_pk_mul_f32 v[96:97], v[96:97], v[32:33] op_sel_hi:[1,0]
  v_pk_mul_f32 v[98:99], v[98:99], v[32:33] op_sel_hi:[1,0]
  v_pk_mul_f32 v[100:101], v[100:101], v[32:33] op_sel_hi:[1,0]
  v_pk_mul_f32 v[102:103], v[102:103], v[32:33] op_sel_hi:[1,0]
  v_pk_mul_f32 v[104:105], v[104:105], v[32:33] op_sel_hi:[1,0]
  v_pk_mul_f32 v[106:107], v[106:107], v[32:33] op_sel_hi:[1,0]
  v_pk_mul_f32 v[108:109], v[108:109], v[32:33] op_sel_hi:[1,0]
  v_pk_mul_f32 v[110:111], v[110:111], v[32:33] op_sel_hi:[1,0]
  v_cvt_pk_bf16_f32 v40, v96, v97
  v_cvt_pk_bf16_f32 v41, v98, v99
  v_cvt_pk_bf16_f32 v42, v100, v101
  v_cvt_pk_bf16_f32 v43, v102, v103
  v_cvt_pk_bf16_f32 v44, v104, v105
  v_cvt_pk_bf16_f32 v45, v106, v107
  v_cvt_pk_bf16_f32 v46, v108, v109
  v_cvt_pk_bf16_f32 v47, v110, v111
  buffer_store_dwordx4 v[40:43], v29, s[24:27], s70 offen
  buffer_store_dwordx4 v[44:47], v29, s[24:27], s71 offen
  s_lshr_b32 s70, s64, 1
  s_mul_i32 s70, s70, 4736
  s_and_b32 s71, s64, 1
  s_lshl_b32 s71, s71, 10
  s_add_u32 s70, s70, s71
  s_lshl_b32 s71, s64, 10
  s_add_u32 s71, s71, 5242880
  s_cmp_lt_u32 s66, 16
  s_cselect_b32 s70, s71, s70
  s_mul_i32 s71, s67, s69
  s_add_u32 s70, s70, s71
  s_add_u32 s71, s70, s69
  v_mul_f32 v32, s68, v24
  v_pk_fma_f32 v[128:129], v[160:161], v[24:25], v[128:129] op_sel:[0,1,0] op_sel_hi:[1,1,1]
  v_pk_fma_f32 v[130:131], v[162:163], v[24:25], v[130:131] op_sel:[0,1,0] op_sel_hi:[1,1,1]
  v_pk_fma_f32 v[132:133], v[164:165], v[24:25], v[132:133] op_sel:[0,1,0] op_sel_hi:[1,1,1]
  v_pk_fma_f32 v[134:135], v[166:167], v[24:25], v[134:135] op_sel:[0,1,0] op_sel_hi:[1,1,1]
  v_pk_fma_f32 v[136:137], v[168:169], v[24:25], v[136:137] op_sel:[0,1,0] op_sel_hi:[1,1,1]
  v_pk_fma_f32 v[138:139], v[170:171], v[24:25], v[138:139] op_sel:[0,1,0] op_sel_hi:[1,1,1]
  v_pk_fma_f32 v[140:141], v[172:173], v[24:25], v[140:141] op_sel:[0,1,0] op_sel_hi:[1,1,1]
  v_pk_fma_f32 v[142:143], v[174:175], v[24:25], v[142:143] op_sel:[0,1,0] op_sel_hi:[1,1,1]
  v_pk_mul_f32 v[128:129], v[128:129], v[32:33] op_sel_hi:[1,0]
  v_pk_mul_f32 v[130:131], v[130:131], v[32:33] op_sel_hi:[1,0]
  v_pk_mul_f32 v[132:133], v[132:133], v[32:33] op_sel_hi:[1,0]
  v_pk_mul_f32 v[134:135], v[134:135], v[32:33] op_sel_hi:[1,0]
  v_pk_mul_f32 v[136:137], v[136:137], v[32:33] op_sel_hi:[1,0]
  v_pk_mul_f32 v[138:139], v[138:139], v[32:33] op_sel_hi:[1,0]
  v_pk_mul_f32 v[140:141], v[140:141], v[32:33] op_sel_hi:[1,0]
  v_pk_mul_f32 v[142:143], v[142:143], v[32:33] op_sel_hi:[1,0]
  v_cvt_pk_bf16_f32 v48, v128, v129
  v_cvt_pk_bf16_f32 v49, v130, v131
  v_cvt_pk_bf16_f32 v50, v132, v133
  v_cvt_pk_bf16_f32 v51, v134, v135
  v_cvt_pk_bf16_f32 v52, v136, v137
  v_cvt_pk_bf16_f32 v53, v138, v139
  v_cvt_pk_bf16_f32 v54, v140, v141
  v_cvt_pk_bf16_f32 v55, v142, v143
  buffer_store_dwordx4 v[48:51], v29, s[24:27], s70 offen
  buffer_store_dwordx4 v[52:55], v29, s[24:27], s71 offen
  s_cmp_lt_u32 s66, 16
  s_cbranch_scc1 k1_kernel_next3
  v_pk_mul_f32 v[56:57], v[96:97], v[96:97]
  v_pk_mul_f32 v[58:59], v[104:105], v[104:105]
  v_pk_fma_f32 v[56:57], v[98:99], v[98:99], v[56:57]
  v_pk_fma_f32 v[58:59], v[106:107], v[106:107], v[58:59]
  v_pk_fma_f32 v[56:57], v[100:101], v[100:101], v[56:57]
  v_pk_fma_f32 v[58:59], v[108:109], v[108:109], v[58:59]
  v_pk_fma_f32 v[56:57], v[102:103], v[102:103], v[56:57]
  v_pk_fma_f32 v[58:59], v[110:111], v[110:111], v[58:59]
  v_pk_mul_f32 v[60:61], v[128:129], v[128:129]
  v_pk_mul_f32 v[62:63], v[136:137], v[136:137]
  v_pk_fma_f32 v[60:61], v[130:131], v[130:131], v[60:61]
  v_pk_fma_f32 v[62:63], v[138:139], v[138:139], v[62:63]
  v_pk_fma_f32 v[60:61], v[132:133], v[132:133], v[60:61]
  v_pk_fma_f32 v[62:63], v[140:141], v[140:141], v[62:63]
  v_pk_fma_f32 v[60:61], v[134:135], v[134:135], v[60:61]
  v_pk_fma_f32 v[62:63], v[142:143], v[142:143], v[62:63]
  v_add_f32 v56, v56, v57
  v_add_f32 v58, v58, v59
  v_add_f32 v60, v60, v61
  v_add_f32 v62, v62, v63
  s_lshl_b32 s70, s67, 8
  s_and_b32 s71, s63, 62
  s_lshl_b32 s71, s71, 2
  v_permlane32_swap_b32 v56, v58
  v_permlane32_swap_b32 v60, v62
  s_add_u32 s70, s70, s71
  s_add_u32 s70, s70, 7602176
  v_add_f32 v56, v56, v58
  v_add_f32 v60, v60, v62
  v_max_f32 v56, v56, v60
  v_lshlrev_b32 v58, 8, v3
  s_nop 0
  v_max_f32_dpp v56, v56, v56 row_shr:1 row_mask:0xf bank_mask:0xf
  s_nop 1
  v_max_f32_dpp v56, v56, v56 row_shr:2 row_mask:0xf bank_mask:0xf
  s_nop 1
  v_max_f32_dpp v56, v56, v56 row_shr:4 row_mask:0xf bank_mask:0xf
  s_nop 1
  v_max_f32_dpp v56, v56, v56 row_shr:8 row_mask:0xf bank_mask:0xf
  s_nop 1
  v_max_f32_dpp v56, v56, v56 row_bcast:15 row_mask:0xa bank_mask:0xf
  s_mov_b32 exec_lo, 0x80000000
  s_mov_b32 exec_hi, 0x80000000
  v_mov_b32 v57, v56
  buffer_store_dwordx2 v[56:57], v58, s[24:27], s70 offen
  s_mov_b64 exec, -1
  s_branch k1_kernel_next3
k1_kernel_rem2:
  s_lshr_b32 s70, s63, 1
  s_mul_i32 s70, s70, 4736
  s_and_b32 s71, s63, 1
  s_lshl_b32 s71, s71, 7
  s_add_u32 s70, s70, s71
  s_add_u32 s70, s70, 4480
  s_lshl_b32 s71, s63, 7
  s_add_u32 s71, s71, 7340032
  s_lshl_b32 s73, s63, 2
  s_add_u32 s73, s73, 7610368
  s_add_u32 s66, s65, 0
  s_and_b32 s67, s66, 15
  s_lshl_b32 s67, s67, 1
  s_lshl_b32 s74, s67, 8
  s_add_u32 s74, s74, s73
  s_cmp_lt_u32 s66, 16
  s_mov_b32 s77, 151552
  s_cselect_b32 s77, 8192, s77
  s_cselect_b32 s78, 0x3eae1a93, 1.0
  s_cselect_b32 s76, s71, s70
  s_cselect_b32 s79, 1073741824, s74
  s_mul_i32 s67, s67, s77
  s_add_u32 s76, s76, s67
  s_cmp_ge_u32 s66, 32
  s_cselect_b32 s76, 1073741824, s76
  s_cselect_b32 s79, 1073741824, s79
  s_add_u32 s66, s65, 1
  s_and_b32 s67, s66, 15
  s_lshl_b32 s67, s67, 1
  s_lshl_b32 s74, s67, 8
  s_add_u32 s74, s74, s73
  s_cmp_lt_u32 s66, 16
  s_mov_b32 s81, 151552
  s_cselect_b32 s81, 8192, s81
  s_cselect_b32 s82, 0x3eae1a93, 1.0
  s_cselect_b32 s80, s71, s70
  s_cselect_b32 s83, 1073741824, s74
  s_mul_i32 s67, s67, s81
  s_add_u32 s80, s80, s67
  s_cmp_ge_u32 s66, 32
  s_cselect_b32 s80, 1073741824, s80
  s_cselect_b32 s83, 1073741824, s83
  s_add_u32 s66, s65, 2
  s_and_b32 s67, s66, 15
  s_lshl_b32 s67, s67, 1
  s_lshl_b32 s74, s67, 8
  s_add_u32 s74, s74, s73
  s_cmp_lt_u32 s66, 16
  s_mov_b32 s85, 151552
  s_cselect_b32 s85, 8192, s85
  s_cselect_b32 s86, 0x3eae1a93, 1.0
  s_cselect_b32 s84, s71, s70
  s_cselect_b32 s87, 1073741824, s74
  s_mul_i32 s67, s67, s85
  s_add_u32 s84, s84, s67
  s_cmp_ge_u32 s66, 32
  s_cselect_b32 s84, 1073741824, s84
  s_cselect_b32 s87, 1073741824, s87
  v_cmp_eq_u32 s[74:75], 1, v3
  v_mov_b32 v32, s76
  v_mov_b32 v33, s77
  v_mov_b32 v34, s78
  v_mov_b32 v35, s79
  v_mov_b32 v36, s80
  v_mov_b32 v37, s81
  v_mov_b32 v38, s82
  v_mov_b32 v39, s83
  v_cndmask_b32 v32, v32, v36, s[74:75]
  v_cndmask_b32 v33, v33, v37, s[74:75]
  v_cndmask_b32 v34, v34, v38, s[74:75]
  v_cndmask_b32 v35, v35, v39, s[74:75]
  v_mov_b32 v36, s84
  v_mov_b32 v39, s87
  v_mov_b32 v37, 1073741824
  v_cndmask_b32 v36, v36, v37, s[74:75]
  v_cndmask_b32 v39, v39, v37, s[74:75]
  v_lshl_add_u32 v32, v2, 2, v32
  v_lshl_add_u32 v36, v2, 2, v36
  v_add_u32 v33, v32, v33
  v_add_u32 v37, s85, v36
  v_mul_f32 v34, v34, v22
  v_mul_f32 v38, s86, v22
  v_fma_f32 v96, v160, v23, v96
  v_fma_f32 v97, v161, v23, v97
  v_fma_f32 v98, v162, v23, v98
  v_fma_f32 v99, v163, v23, v99
  v_fma_f32 v100, v164, v23, v100
  v_fma_f32 v101, v165, v23, v101
  v_fma_f32 v102, v166, v23, v102
  v_fma_f32 v103, v167, v23, v103
  v_mul_f32 v96, v96, v34
  v_mul_f32 v97, v97, v34
  v_mul_f32 v98, v98, v34
  v_mul_f32 v99, v99, v34
  v_mul_f32 v100, v100, v38
  v_mul_f32 v101, v101, v38
  v_mul_f32 v102, v102, v38
  v_mul_f32 v103, v103, v38
  v_cvt_pk_bf16_f32 v40, v96, v97
  v_mul_f32 v44, v96, v96
  v_fma_f32 v44, v97, v97, v44
  v_cvt_pk_bf16_f32 v41, v98, v99
  v_mul_f32 v45, v98, v98
  v_fma_f32 v45, v99, v99, v45
  v_cvt_pk_bf16_f32 v42, v100, v101
  v_mul_f32 v46, v100, v100
  v_fma_f32 v46, v101, v101, v46
  v_cvt_pk_bf16_f32 v43, v102, v103
  v_mul_f32 v47, v102, v102
  v_fma_f32 v47, v103, v103, v47
  buffer_store_dword v40, v32, s[24:27], 0 offen
  buffer_store_dword v41, v33, s[24:27], 0 offen
  buffer_store_dword v42, v36, s[24:27], 0 offen
  buffer_store_dword v43, v37, s[24:27], 0 offen
  v_max_f32_dpp v44, v44, v44 row_shr:1 row_mask:0xf bank_mask:0xf
  v_max_f32_dpp v45, v45, v45 row_shr:1 row_mask:0xf bank_mask:0xf
  v_max_f32_dpp v46, v46, v46 row_shr:1 row_mask:0xf bank_mask:0xf
  v_max_f32_dpp v47, v47, v47 row_shr:1 row_mask:0xf bank_mask:0xf
  v_max_f32_dpp v44, v44, v44 row_shr:2 row_mask:0xf bank_mask:0xf
  v_max_f32_dpp v45, v45, v45 row_shr:2 row_mask:0xf bank_mask:0xf
  v_max_f32_dpp v46, v46, v46 row_shr:2 row_mask:0xf bank_mask:0xf
  v_max_f32_dpp v47, v47, v47 row_shr:2 row_mask:0xf bank_mask:0xf
  v_max_f32_dpp v44, v44, v44 row_shr:4 row_mask:0xf bank_mask:0xf
  v_max_f32_dpp v45, v45, v45 row_shr:4 row_mask:0xf bank_mask:0xf
  v_max_f32_dpp v46, v46, v46 row_shr:4 row_mask:0xf bank_mask:0xf
  v_max_f32_dpp v47, v47, v47 row_shr:4 row_mask:0xf bank_mask:0xf
  v_max_f32_dpp v44, v44, v44 row_shr:8 row_mask:0xf bank_mask:0xf
  v_max_f32_dpp v45, v45, v45 row_shr:8 row_mask:0xf bank_mask:0xf
  v_max_f32_dpp v46, v46, v46 row_shr:8 row_mask:0xf bank_mask:0xf
  v_max_f32_dpp v47, v47, v47 row_shr:8 row_mask:0xf bank_mask:0xf
  v_max_f32_dpp v44, v44, v44 row_bcast:15 row_mask:0xa bank_mask:0xf
  v_max_f32_dpp v45, v45, v45 row_bcast:15 row_mask:0xa bank_mask:0xf
  v_max_f32_dpp v46, v46, v46 row_bcast:15 row_mask:0xa bank_mask:0xf
  v_max_f32_dpp v47, v47, v47 row_bcast:15 row_mask:0xa bank_mask:0xf
  s_mov_b32 exec_lo, 0x80000000
  s_mov_b32 exec_hi, 0x80000000
  buffer_store_dword v44, v35, s[24:27], 0 offen
  buffer_store_dword v45, v35, s[24:27], 0 offen offset:256
  buffer_store_dword v46, v39, s[24:27], 0 offen
  buffer_store_dword v47, v39, s[24:27], 0 offen offset:256
  s_mov_b64 exec, -1
  s_lshr_b32 s70, s64, 1
  s_mul_i32 s70, s70, 4736
  s_and_b32 s71, s64, 1
  s_lshl_b32 s71, s71, 7
  s_add_u32 s70, s70, s71
  s_add_u32 s70, s70, 4480
  s_lshl_b32 s71, s64, 7
  s_add_u32 s71, s71, 7340032
  s_lshl_b32 s73, s64, 2
  s_add_u32 s73, s73, 7610368
  s_add_u32 s66, s65, 0
  s_and_b32 s67, s66, 15
  s_lshl_b32 s67, s67, 1
  s_lshl_b32 s74, s67, 8
  s_add_u32 s74, s74, s73
  s_cmp_lt_u32 s66, 16
  s_mov_b32 s77, 151552
  s_cselect_b32 s77, 8192, s77
  s_cselect_b32 s78, 0x3eae1a93, 1.0
  s_cselect_b32 s76, s71, s70
  s_cselect_b32 s79, 1073741824, s74
  s_mul_i32 s67, s67, s77
  s_add_u32 s76, s76, s67
  s_cmp_ge_u32 s66, 32
  s_cselect_b32 s76, 1073741824, s76
  s_cselect_b32 s79, 1073741824, s79
  s_add_u32 s66, s65, 1
  s_and_b32 s67, s66, 15
  s_lshl_b32 s67, s67, 1
  s_lshl_b32 s74, s67, 8
  s_add_u32 s74, s74, s73
  s_cmp_lt_u32 s66, 16
  s_mov_b32 s81, 151552
  s_cselect_b32 s81, 8192, s81
  s_cselect_b32 s82, 0x3eae1a93, 1.0
  s_cselect_b32 s80, s71, s70
  s_cselect_b32 s83, 1073741824, s74
  s_mul_i32 s67, s67, s81
  s_add_u32 s80, s80, s67
  s_cmp_ge_u32 s66, 32
  s_cselect_b32 s80, 1073741824, s80
  s_cselect_b32 s83, 1073741824, s83
  s_add_u32 s66, s65, 2
  s_and_b32 s67, s66, 15
  s_lshl_b32 s67, s67, 1
  s_lshl_b32 s74, s67, 8
  s_add_u32 s74, s74, s73
  s_cmp_lt_u32 s66, 16
  s_mov_b32 s85, 151552
  s_cselect_b32 s85, 8192, s85
  s_cselect_b32 s86, 0x3eae1a93, 1.0
  s_cselect_b32 s84, s71, s70
  s_cselect_b32 s87, 1073741824, s74
  s_mul_i32 s67, s67, s85
  s_add_u32 s84, s84, s67
  s_cmp_ge_u32 s66, 32
  s_cselect_b32 s84, 1073741824, s84
  s_cselect_b32 s87, 1073741824, s87
  v_cmp_eq_u32 s[74:75], 1, v3
  v_mov_b32 v32, s76
  v_mov_b32 v33, s77
  v_mov_b32 v34, s78
  v_mov_b32 v35, s79
  v_mov_b32 v36, s80
  v_mov_b32 v37, s81
  v_mov_b32 v38, s82
  v_mov_b32 v39, s83
  v_cndmask_b32 v32, v32, v36, s[74:75]
  v_cndmask_b32 v33, v33, v37, s[74:75]
  v_cndmask_b32 v34, v34, v38, s[74:75]
  v_cndmask_b32 v35, v35, v39, s[74:75]
  v_mov_b32 v36, s84
  v_mov_b32 v39, s87
  v_mov_b32 v37, 1073741824
  v_cndmask_b32 v36, v36, v37, s[74:75]
  v_cndmask_b32 v39, v39, v37, s[74:75]
  v_lshl_add_u32 v32, v2, 2, v32
  v_lshl_add_u32 v36, v2, 2, v36
  v_add_u32 v33, v32, v33
  v_add_u32 v37, s85, v36
  v_mul_f32 v34, v34, v24
  v_mul_f32 v38, s86, v24
  v_fma_f32 v128, v160, v25, v128
  v_fma_f32 v129, v161, v25, v129
  v_fma_f32 v130, v162, v25, v130
  v_fma_f32 v131, v163, v25, v131
  v_fma_f32 v132, v164, v25, v132
  v_fma_f32 v133, v165, v25, v133
  v_fma_f32 v134, v166, v25, v134
  v_fma_f32 v135, v167, v25, v135
  v_mul_f32 v128, v128, v34
  v_mul_f32 v129, v129, v34
  v_mul_f32 v130, v130, v34
  v_mul_f32 v131, v131, v34
  v_mul_f32 v132, v132, v38
  v_mul_f32 v133, v133, v38
  v_mul_f32 v134, v134, v38
  v_mul_f32 v135, v135, v38
  v_cvt_pk_bf16_f32 v40, v128, v129
  v_mul_f32 v44, v128, v128
  v_fma_f32 v44, v129, v129, v44
  v_cvt_pk_bf16_f32 v41, v130, v131
  v_mul_f32 v45, v130, v130
  v_fma_f32 v45, v131, v131, v45
  v_cvt_pk_bf16_f32 v42, v132, v133
  v_mul_f32 v46, v132, v132
  v_fma_f32 v46, v133, v133, v46
  v_cvt_pk_bf16_f32 v43, v134, v135
  v_mul_f32 v47, v134, v134
  v_fma_f32 v47, v135, v135, v47
  buffer_store_dword v40, v32, s[24:27], 0 offen
  buffer_store_dword v41, v33, s[24:27], 0 offen
  buffer_store_dword v42, v36, s[24:27], 0 offen
  buffer_store_dword v43, v37, s[24:27], 0 offen
  v_max_f32_dpp v44, v44, v44 row_shr:1 row_mask:0xf bank_mask:0xf
  v_max_f32_dpp v45, v45, v45 row_shr:1 row_mask:0xf bank_mask:0xf
  v_max_f32_dpp v46, v46, v46 row_shr:1 row_mask:0xf bank_mask:0xf
  v_max_f32_dpp v47, v47, v47 row_shr:1 row_mask:0xf bank_mask:0xf
  v_max_f32_dpp v44, v44, v44 row_shr:2 row_mask:0xf bank_mask:0xf
  v_max_f32_dpp v45, v45, v45 row_shr:2 row_mask:0xf bank_mask:0xf
  v_max_f32_dpp v46, v46, v46 row_shr:2 row_mask:0xf bank_mask:0xf
  v_max_f32_dpp v47, v47, v47 row_shr:2 row_mask:0xf bank_mask:0xf
  v_max_f32_dpp v44, v44, v44 row_shr:4 row_mask:0xf bank_mask:0xf
  v_max_f32_dpp v45, v45, v45 row_shr:4 row_mask:0xf bank_mask:0xf
  v_max_f32_dpp v46, v46, v46 row_shr:4 row_mask:0xf bank_mask:0xf
  v_max_f32_dpp v47, v47, v47 row_shr:4 row_mask:0xf bank_mask:0xf
  v_max_f32_dpp v44, v44, v44 row_shr:8 row_mask:0xf bank_mask:0xf
  v_max_f32_dpp v45, v45, v45 row_shr:8 row_mask:0xf bank_mask:0xf
  v_max_f32_dpp v46, v46, v46 row_shr:8 row_mask:0xf bank_mask:0xf
  v_max_f32_dpp v47, v47, v47 row_shr:8 row_mask:0xf bank_mask:0xf
  v_max_f32_dpp v44, v44, v44 row_bcast:15 row_mask:0xa bank_mask:0xf
  v_max_f32_dpp v45, v45, v45 row_bcast:15 row_mask:0xa bank_mask:0xf
  v_max_f32_dpp v46, v46, v46 row_bcast:15 row_mask:0xa bank_mask:0xf
  v_max_f32_dpp v47, v47, v47 row_bcast:15 row_mask:0xa bank_mask:0xf
  s_mov_b32 exec_lo, 0x80000000
  s_mov_b32 exec_hi, 0x80000000
  buffer_store_dword v44, v35, s[24:27], 0 offen
  buffer_store_dword v45, v35, s[24:27], 0 offen offset:256
  buffer_store_dword v46, v39, s[24:27], 0 offen
  buffer_store_dword v47, v39, s[24:27], 0 offen offset:256
  s_mov_b64 exec, -1
k1_kernel_next3:
  s_cmp_eq_u32 s62, 3
  s_cbranch_scc1 k1_kernel_rem4
  s_add_u32 s66, s65, s62
  s_cmp_ge_u32 s66, 32
  s_cbranch_scc1 k1_kernel_next5
  s_and_b32 s67, s66, 15
  s_lshl_b32 s67, s67, 1
  s_cmp_lt_u32 s66, 16
  s_cselect_b32 s68, 0x3eae1a93, 1.0
  s_mov_b32 s69, 151552
  s_cselect_b32 s69, 65536, s69
  s_lshr_b32 s70, s63, 1
  s_mul_i32 s70, s70, 4736
  s_and_b32 s71, s63, 1
  s_lshl_b32 s71, s71, 10
  s_add_u32 s70, s70, s71
  s_lshl_b32 s71, s63, 10
  s_add_u32 s71, s71, 5242880
  s_cmp_lt_u32 s66, 16
  s_cselect_b32 s70, s71, s70
  s_mul_i32 s71, s67, s69
  s_add_u32 s70, s70, s71
  s_add_u32 s71, s70, s69
  v_mul_f32 v32, s68, v22
  v_pk_fma_f32 v[112:113], v[176:177], v[22:23], v[112:113] op_sel:[0,1,0] op_sel_hi:[1,1,1]
  v_pk_fma_f32 v[114:115], v[178:179], v[22:23], v[114:115] op_sel:[0,1,0] op_sel_hi:[1,1,1]
  v_pk_fma_f32 v[116:117], v[180:181], v[22:23], v[116:117] op_sel:[0,1,0] op_sel_hi:[1,1,1]
  v_pk_fma_f32 v[118:119], v[182:183], v[22:23], v[118:119] op_sel:[0,1,0] op_sel_hi:[1,1,1]
  v_pk_fma_f32 v[120:121], v[184:185], v[22:23], v[120:121] op_sel:[0,1,0] op_sel_hi:[1,1,1]
  v_pk_fma_f32 v[122:123], v[186:187], v[22:23], v[122:123] op_sel:[0,1,0] op_sel_hi:[1,1,1]
  v_pk_fma_f32 v[124:125], v[188:189], v[22:23], v[124:125] op_sel:[0,1,0] op_sel_hi:[1,1,1]
  v_pk_fma_f32 v[126:127], v[190:191], v[22:23], v[126:127] op_sel:[0,1,0] op_sel_hi:[1,1,1]
  v_pk_mul_f32 v[112:113], v[112:113], v[32:33] op_sel_hi:[1,0]
  v_pk_mul_f32 v[114:115], v[114:115], v[32:33] op_sel_hi:[1,0]
  v_pk_mul_f32 v[116:117], v[116:117], v[32:33] op_sel_hi:[1,0]
  v_pk_mul_f32 v[118:119], v[118:119], v[32:33] op_sel_hi:[1,0]
  v_pk_mul_f32 v[120:121], v[120:121], v[32:33] op_sel_hi:[1,0]
  v_pk_mul_f32 v[122:123], v[122:123], v[32:33] op_sel_hi:[1,0]
  v_pk_mul_f32 v[124:125], v[124:125], v[32:33] op_sel_hi:[1,0]
  v_pk_mul_f32 v[126:127], v[126:127], v[32:33] op_sel_hi:[1,0]
  v_cvt_pk_bf16_f32 v40, v112, v113
  v_cvt_pk_bf16_f32 v41, v114, v115
  v_cvt_pk_bf16_f32 v42, v116, v117
  v_cvt_pk_bf16_f32 v43, v118, v119
  v_cvt_pk_bf16_f32 v44, v120, v121
  v_cvt_pk_bf16_f32 v45, v122, v123
  v_cvt_pk_bf16_f32 v46, v124, v125
  v_cvt_pk_bf16_f32 v47, v126, v127
  buffer_store_dwordx4 v[40:43], v29, s[24:27], s70 offen
  buffer_store_dwordx4 v[44:47], v29, s[24:27], s71 offen
  s_lshr_b32 s70, s64, 1
  s_mul_i32 s70, s70, 4736
  s_and_b32 s71, s64, 1
  s_lshl_b32 s71, s71, 10
  s_add_u32 s70, s70, s71
  s_lshl_b32 s71, s64, 10
  s_add_u32 s71, s71, 5242880
  s_cmp_lt_u32 s66, 16
  s_cselect_b32 s70, s71, s70
  s_mul_i32 s71, s67, s69
  s_add_u32 s70, s70, s71
  s_add_u32 s71, s70, s69
  v_mul_f32 v32, s68, v24
  v_pk_fma_f32 v[144:145], v[176:177], v[24:25], v[144:145] op_sel:[0,1,0] op_sel_hi:[1,1,1]
  v_pk_fma_f32 v[146:147], v[178:179], v[24:25], v[146:147] op_sel:[0,1,0] op_sel_hi:[1,1,1]
  v_pk_fma_f32 v[148:149], v[180:181], v[24:25], v[148:149] op_sel:[0,1,0] op_sel_hi:[1,1,1]
  v_pk_fma_f32 v[150:151], v[182:183], v[24:25], v[150:151] op_sel:[0,1,0] op_sel_hi:[1,1,1]
  v_pk_fma_f32 v[152:153], v[184:185], v[24:25], v[152:153] op_sel:[0,1,0] op_sel_hi:[1,1,1]
  v_pk_fma_f32 v[154:155], v[186:187], v[24:25], v[154:155] op_sel:[0,1,0] op_sel_hi:[1,1,1]
  v_pk_fma_f32 v[156:157], v[188:189], v[24:25], v[156:157] op_sel:[0,1,0] op_sel_hi:[1,1,1]
  v_pk_fma_f32 v[158:159], v[190:191], v[24:25], v[158:159] op_sel:[0,1,0] op_sel_hi:[1,1,1]
  v_pk_mul_f32 v[144:145], v[144:145], v[32:33] op_sel_hi:[1,0]
  v_pk_mul_f32 v[146:147], v[146:147], v[32:33] op_sel_hi:[1,0]
  v_pk_mul_f32 v[148:149], v[148:149], v[32:33] op_sel_hi:[1,0]
  v_pk_mul_f32 v[150:151], v[150:151], v[32:33] op_sel_hi:[1,0]
  v_pk_mul_f32 v[152:153], v[152:153], v[32:33] op_sel_hi:[1,0]
  v_pk_mul_f32 v[154:155], v[154:155], v[32:33] op_sel_hi:[1,0]
  v_pk_mul_f32 v[156:157], v[156:157], v[32:33] op_sel_hi:[1,0]
  v_pk_mul_f32 v[158:159], v[158:159], v[32:33] op_sel_hi:[1,0]
  v_cvt_pk_bf16_f32 v48, v144, v145
  v_cvt_pk_bf16_f32 v49, v146, v147
  v_cvt_pk_bf16_f32 v50, v148, v149
  v_cvt_pk_bf16_f32 v51, v150, v151
  v_cvt_pk_bf16_f32 v52, v152, v153
  v_cvt_pk_bf16_f32 v53, v154, v155
  v_cvt_pk_bf16_f32 v54, v156, v157
  v_cvt_pk_bf16_f32 v55, v158, v159
  buffer_store_dwordx4 v[48:51], v29, s[24:27], s70 offen
  buffer_store_dwordx4 v[52:55], v29, s[24:27], s71 offen
  s_cmp_lt_u32 s66, 16
  s_cbranch_scc1 k1_kernel_next5
  v_pk_mul_f32 v[56:57], v[112:113], v[112:113]
  v_pk_mul_f32 v[58:59], v[120:121], v[120:121]
  v_pk_fma_f32 v[56:57], v[114:115], v[114:115], v[56:57]
  v_pk_fma_f32 v[58:59], v[122:123], v[122:123], v[58:59]
  v_pk_fma_f32 v[56:57], v[116:117], v[116:117], v[56:57]
  v_pk_fma_f32 v[58:59], v[124:125], v[124:125], v[58:59]
  v_pk_fma_f32 v[56:57], v[118:119], v[118:119], v[56:57]
  v_pk_fma_f32 v[58:59], v[126:127], v[126:127], v[58:59]
  v_pk_mul_f32 v[60:61], v[144:145], v[144:145]
  v_pk_mul_f32 v[62:63], v[152:153], v[152:153]
  v_pk_fma_f32 v[60:61], v[146:147], v[146:147], v[60:61]
  v_pk_fma_f32 v[62:63], v[154:155], v[154:155], v[62:63]
  v_pk_fma_f32 v[60:61], v[148:149], v[148:149], v[60:61]
  v_pk_fma_f32 v[62:63], v[156:157], v[156:157], v[62:63]
  v_pk_fma_f32 v[60:61], v[150:151], v[150:151], v[60:61]
  v_pk_fma_f32 v[62:63], v[158:159], v[158:159], v[62:63]
  v_add_f32 v56, v56, v57
  v_add_f32 v58, v58, v59
  v_add_f32 v60, v60, v61
  v_add_f32 v62, v62, v63
  s_lshl_b32 s70, s67, 8
  s_and_b32 s71, s63, 62
  s_lshl_b32 s71, s71, 2
  v_permlane32_swap_b32 v56, v58
  v_permlane32_swap_b32 v60, v62
  s_add_u32 s70, s70, s71
  s_add_u32 s70, s70, 7602176
  v_add_f32 v56, v56, v58
  v_add_f32 v60, v60, v62
  v_max_f32 v56, v56, v60
  v_lshlrev_b32 v58, 8, v3
  s_nop 0
  v_max_f32_dpp v56, v56, v56 row_shr:1 row_mask:0xf bank_mask:0xf
  s_nop 1
  v_max_f32_dpp v56, v56, v56 row_shr:2 row_mask:0xf bank_mask:0xf
  s_nop 1
  v_max_f32_dpp v56, v56, v56 row_shr:4 row_mask:0xf bank_mask:0xf
  s_nop 1
  v_max_f32_dpp v56, v56, v56 row_shr:8 row_mask:0xf bank_mask:0xf
  s_nop 1
  v_max_f32_dpp v56, v56, v56 row_bcast:15 row_mask:0xa bank_mask:0xf
  s_mov_b32 exec_lo, 0x80000000
  s_mov_b32 exec_hi, 0x80000000
  v_mov_b32 v57, v56
  buffer_store_dwordx2 v[56:57], v58, s[24:27], s70 offen
  s_mov_b64 exec, -1
  s_branch k1_kernel_next5
k1_kernel_rem4:
  s_lshr_b32 s70, s63, 1
  s_mul_i32 s70, s70, 4736
  s_and_b32 s71, s63, 1
  s_lshl_b32 s71, s71, 7
  s_add_u32 s70, s70, s71
  s_add_u32 s70, s70, 4480
  s_lshl_b32 s71, s63, 7
  s_add_u32 s71, s71, 7340032
  s_lshl_b32 s73, s63, 2
  s_add_u32 s73, s73, 7610368
  s_add_u32 s66, s65, 0
  s_and_b32 s67, s66, 15
  s_lshl_b32 s67, s67, 1
  s_lshl_b32 s74, s67, 8
  s_add_u32 s74, s74, s73
  s_cmp_lt_u32 s66, 16
  s_mov_b32 s77, 151552
  s_cselect_b32 s77, 8192, s77
  s_cselect_b32 s78, 0x3eae1a93, 1.0
  s_cselect_b32 s76, s71, s70
  s_cselect_b32 s79, 1073741824, s74
  s_mul_i32 s67, s67, s77
  s_add_u32 s76, s76, s67
  s_cmp_ge_u32 s66, 32
  s_cselect_b32 s76, 1073741824, s76
  s_cselect_b32 s79, 1073741824, s79
  s_add_u32 s66, s65, 1
  s_and_b32 s67, s66, 15
  s_lshl_b32 s67, s67, 1
  s_lshl_b32 s74, s67, 8
  s_add_u32 s74, s74, s73
  s_cmp_lt_u32 s66, 16
  s_mov_b32 s81, 151552
  s_cselect_b32 s81, 8192, s81
  s_cselect_b32 s82, 0x3eae1a93, 1.0
  s_cselect_b32 s80, s71, s70
  s_cselect_b32 s83, 1073741824, s74
  s_mul_i32 s67, s67, s81
  s_add_u32 s80, s80, s67
  s_cmp_ge_u32 s66, 32
  s_cselect_b32 s80, 1073741824, s80
  s_cselect_b32 s83, 1073741824, s83
  s_add_u32 s66, s65, 2
  s_and_b32 s67, s66, 15
  s_lshl_b32 s67, s67, 1
  s_lshl_b32 s74, s67, 8
  s_add_u32 s74, s74, s73
  s_cmp_lt_u32 s66, 16
  s_mov_b32 s85, 151552
  s_cselect_b32 s85, 8192, s85
  s_cselect_b32 s86, 0x3eae1a93, 1.0
  s_cselect_b32 s84, s71, s70
  s_cselect_b32 s87, 1073741824, s74
  s_mul_i32 s67, s67, s85
  s_add_u32 s84, s84, s67
  s_cmp_ge_u32 s66, 32
  s_cselect_b32 s84, 1073741824, s84
  s_cselect_b32 s87, 1073741824, s87
  v_cmp_eq_u32 s[74:75], 1, v3
  v_mov_b32 v32, s76
  v_mov_b32 v33, s77
  v_mov_b32 v34, s78
  v_mov_b32 v35, s79
  v_mov_b32 v36, s80
  v_mov_b32 v37, s81
  v_mov_b32 v38, s82
  v_mov_b32 v39, s83
  v_cndmask_b32 v32, v32, v36, s[74:75]
  v_cndmask_b32 v33, v33, v37, s[74:75]
  v_cndmask_b32 v34, v34, v38, s[74:75]
  v_cndmask_b32 v35, v35, v39, s[74:75]
  v_mov_b32 v36, s84
  v_mov_b32 v39, s87
  v_mov_b32 v37, 1073741824
  v_cndmask_b32 v36, v36, v37, s[74:75]
  v_cndmask_b32 v39, v39, v37, s[74:75]
  v_lshl_add_u32 v32, v2, 2, v32
  v_lshl_add_u32 v36, v2, 2, v36
  v_add_u32 v33, v32, v33
  v_add_u32 v37, s85, v36
  v_mul_f32 v34, v34, v22
  v_mul_f32 v38, s86, v22
  v_fma_f32 v112, v176, v23, v112
  v_fma_f32 v113, v177, v23, v113
  v_fma_f32 v114, v178, v23, v114
  v_fma_f32 v115, v179, v23, v115
  v_fma_f32 v116, v180, v23, v116
  v_fma_f32 v117, v181, v23, v117
  v_fma_f32 v118, v182, v23, v118
  v_fma_f32 v119, v183, v23, v119
  v_mul_f32 v112, v112, v34
  v_mul_f32 v113, v113, v34
  v_mul_f32 v114, v114, v34
  v_mul_f32 v115, v115, v34
  v_mul_f32 v116, v116, v38
  v_mul_f32 v117, v117, v38
  v_mul_f32 v118, v118, v38
  v_mul_f32 v119, v119, v38
  v_cvt_pk_bf16_f32 v40, v112, v113
  v_mul_f32 v44, v112, v112
  v_fma_f32 v44, v113, v113, v44
  v_cvt_pk_bf16_f32 v41, v114, v115
  v_mul_f32 v45, v114, v114
  v_fma_f32 v45, v115, v115, v45
  v_cvt_pk_bf16_f32 v42, v116, v117
  v_mul_f32 v46, v116, v116
  v_fma_f32 v46, v117, v117, v46
  v_cvt_pk_bf16_f32 v43, v118, v119
  v_mul_f32 v47, v118, v118
  v_fma_f32 v47, v119, v119, v47
  buffer_store_dword v40, v32, s[24:27], 0 offen
  buffer_store_dword v41, v33, s[24:27], 0 offen
  buffer_store_dword v42, v36, s[24:27], 0 offen
  buffer_store_dword v43, v37, s[24:27], 0 offen
  v_max_f32_dpp v44, v44, v44 row_shr:1 row_mask:0xf bank_mask:0xf
  v_max_f32_dpp v45, v45, v45 row_shr:1 row_mask:0xf bank_mask:0xf
  v_max_f32_dpp v46, v46, v46 row_shr:1 row_mask:0xf bank_mask:0xf
  v_max_f32_dpp v47, v47, v47 row_shr:1 row_mask:0xf bank_mask:0xf
  v_max_f32_dpp v44, v44, v44 row_shr:2 row_mask:0xf bank_mask:0xf
  v_max_f32_dpp v45, v45, v45 row_shr:2 row_mask:0xf bank_mask:0xf
  v_max_f32_dpp v46, v46, v46 row_shr:2 row_mask:0xf bank_mask:0xf
  v_max_f32_dpp v47, v47, v47 row_shr:2 row_mask:0xf bank_mask:0xf
  v_max_f32_dpp v44, v44, v44 row_shr:4 row_mask:0xf bank_mask:0xf
  v_max_f32_dpp v45, v45, v45 row_shr:4 row_mask:0xf bank_mask:0xf
  v_max_f32_dpp v46, v46, v46 row_shr:4 row_mask:0xf bank_mask:0xf
  v_max_f32_dpp v47, v47, v47 row_shr:4 row_mask:0xf bank_mask:0xf
  v_max_f32_dpp v44, v44, v44 row_shr:8 row_mask:0xf bank_mask:0xf
  v_max_f32_dpp v45, v45, v45 row_shr:8 row_mask:0xf bank_mask:0xf
  v_max_f32_dpp v46, v46, v46 row_shr:8 row_mask:0xf bank_mask:0xf
  v_max_f32_dpp v47, v47, v47 row_shr:8 row_mask:0xf bank_mask:0xf
  v_max_f32_dpp v44, v44, v44 row_bcast:15 row_mask:0xa bank_mask:0xf
  v_max_f32_dpp v45, v45, v45 row_bcast:15 row_mask:0xa bank_mask:0xf
  v_max_f32_dpp v46, v46, v46 row_bcast:15 row_mask:0xa bank_mask:0xf
  v_max_f32_dpp v47, v47, v47 row_bcast:15 row_mask:0xa bank_mask:0xf
  s_mov_b32 exec_lo, 0x80000000
  s_mov_b32 exec_hi, 0x80000000
  buffer_store_dword v44, v35, s[24:27], 0 offen
  buffer_store_dword v45, v35, s[24:27], 0 offen offset:256
  buffer_store_dword v46, v39, s[24:27], 0 offen
  buffer_store_dword v47, v39, s[24:27], 0 offen offset:256
  s_mov_b64 exec, -1
  s_lshr_b32 s70, s64, 1
  s_mul_i32 s70, s70, 4736
  s_and_b32 s71, s64, 1
  s_lshl_b32 s71, s71, 7
  s_add_u32 s70, s70, s71
  s_add_u32 s70, s70, 4480
  s_lshl_b32 s71, s64, 7
  s_add_u32 s71, s71, 7340032
  s_lshl_b32 s73, s64, 2
  s_add_u32 s73, s73, 7610368
  s_add_u32 s66, s65, 0
  s_and_b32 s67, s66, 15
  s_lshl_b32 s67, s67, 1
  s_lshl_b32 s74, s67, 8
  s_add_u32 s74, s74, s73
  s_cmp_lt_u32 s66, 16
  s_mov_b32 s77, 151552
  s_cselect_b32 s77, 8192, s77
  s_cselect_b32 s78, 0x3eae1a93, 1.0
  s_cselect_b32 s76, s71, s70
  s_cselect_b32 s79, 1073741824, s74
  s_mul_i32 s67, s67, s77
  s_add_u32 s76, s76, s67
  s_cmp_ge_u32 s66, 32
  s_cselect_b32 s76, 1073741824, s76
  s_cselect_b32 s79, 1073741824, s79
  s_add_u32 s66, s65, 1
  s_and_b32 s67, s66, 15
  s_lshl_b32 s67, s67, 1
  s_lshl_b32 s74, s67, 8
  s_add_u32 s74, s74, s73
  s_cmp_lt_u32 s66, 16
  s_mov_b32 s81, 151552
  s_cselect_b32 s81, 8192, s81
  s_cselect_b32 s82, 0x3eae1a93, 1.0
  s_cselect_b32 s80, s71, s70
  s_cselect_b32 s83, 1073741824, s74
  s_mul_i32 s67, s67, s81
  s_add_u32 s80, s80, s67
  s_cmp_ge_u32 s66, 32
  s_cselect_b32 s80, 1073741824, s80
  s_cselect_b32 s83, 1073741824, s83
  s_add_u32 s66, s65, 2
  s_and_b32 s67, s66, 15
  s_lshl_b32 s67, s67, 1
  s_lshl_b32 s74, s67, 8
  s_add_u32 s74, s74, s73
  s_cmp_lt_u32 s66, 16
  s_mov_b32 s85, 151552
  s_cselect_b32 s85, 8192, s85
  s_cselect_b32 s86, 0x3eae1a93, 1.0
  s_cselect_b32 s84, s71, s70
  s_cselect_b32 s87, 1073741824, s74
  s_mul_i32 s67, s67, s85
  s_add_u32 s84, s84, s67
  s_cmp_ge_u32 s66, 32
  s_cselect_b32 s84, 1073741824, s84
  s_cselect_b32 s87, 1073741824, s87
  v_cmp_eq_u32 s[74:75], 1, v3
  v_mov_b32 v32, s76
  v_mov_b32 v33, s77
  v_mov_b32 v34, s78
  v_mov_b32 v35, s79
  v_mov_b32 v36, s80
  v_mov_b32 v37, s81
  v_mov_b32 v38, s82
  v_mov_b32 v39, s83
  v_cndmask_b32 v32, v32, v36, s[74:75]
  v_cndmask_b32 v33, v33, v37, s[74:75]
  v_cndmask_b32 v34, v34, v38, s[74:75]
  v_cndmask_b32 v35, v35, v39, s[74:75]
  v_mov_b32 v36, s84
  v_mov_b32 v39, s87
  v_mov_b32 v37, 1073741824
  v_cndmask_b32 v36, v36, v37, s[74:75]
  v_cndmask_b32 v39, v39, v37, s[74:75]
  v_lshl_add_u32 v32, v2, 2, v32
  v_lshl_add_u32 v36, v2, 2, v36
  v_add_u32 v33, v32, v33
  v_add_u32 v37, s85, v36
  v_mul_f32 v34, v34, v24
  v_mul_f32 v38, s86, v24
  v_fma_f32 v144, v176, v25, v144
  v_fma_f32 v145, v177, v25, v145
  v_fma_f32 v146, v178, v25, v146
  v_fma_f32 v147, v179, v25, v147
  v_fma_f32 v148, v180, v25, v148
  v_fma_f32 v149, v181, v25, v149
  v_fma_f32 v150, v182, v25, v150
  v_fma_f32 v151, v183, v25, v151
  v_mul_f32 v144, v144, v34
  v_mul_f32 v145, v145, v34
  v_mul_f32 v146, v146, v34
  v_mul_f32 v147, v147, v34
  v_mul_f32 v148, v148, v38
  v_mul_f32 v149, v149, v38
  v_mul_f32 v150, v150, v38
  v_mul_f32 v151, v151, v38
  v_cvt_pk_bf16_f32 v40, v144, v145
  v_mul_f32 v44, v144, v144
  v_fma_f32 v44, v145, v145, v44
  v_cvt_pk_bf16_f32 v41, v146, v147
  v_mul_f32 v45, v146, v146
  v_fma_f32 v45, v147, v147, v45
  v_cvt_pk_bf16_f32 v42, v148, v149
  v_mul_f32 v46, v148, v148
  v_fma_f32 v46, v149, v149, v46
  v_cvt_pk_bf16_f32 v43, v150, v151
  v_mul_f32 v47, v150, v150
  v_fma_f32 v47, v151, v151, v47
  buffer_store_dword v40, v32, s[24:27], 0 offen
  buffer_store_dword v41, v33, s[24:27], 0 offen
  buffer_store_dword v42, v36, s[24:27], 0 offen
  buffer_store_dword v43, v37, s[24:27], 0 offen
  v_max_f32_dpp v44, v44, v44 row_shr:1 row_mask:0xf bank_mask:0xf
  v_max_f32_dpp v45, v45, v45 row_shr:1 row_mask:0xf bank_mask:0xf
  v_max_f32_dpp v46, v46, v46 row_shr:1 row_mask:0xf bank_mask:0xf
  v_max_f32_dpp v47, v47, v47 row_shr:1 row_mask:0xf bank_mask:0xf
  v_max_f32_dpp v44, v44, v44 row_shr:2 row_mask:0xf bank_mask:0xf
  v_max_f32_dpp v45, v45, v45 row_shr:2 row_mask:0xf bank_mask:0xf
  v_max_f32_dpp v46, v46, v46 row_shr:2 row_mask:0xf bank_mask:0xf
  v_max_f32_dpp v47, v47, v47 row_shr:2 row_mask:0xf bank_mask:0xf
  v_max_f32_dpp v44, v44, v44 row_shr:4 row_mask:0xf bank_mask:0xf
  v_max_f32_dpp v45, v45, v45 row_shr:4 row_mask:0xf bank_mask:0xf
  v_max_f32_dpp v46, v46, v46 row_shr:4 row_mask:0xf bank_mask:0xf
  v_max_f32_dpp v47, v47, v47 row_shr:4 row_mask:0xf bank_mask:0xf
  v_max_f32_dpp v44, v44, v44 row_shr:8 row_mask:0xf bank_mask:0xf
  v_max_f32_dpp v45, v45, v45 row_shr:8 row_mask:0xf bank_mask:0xf
  v_max_f32_dpp v46, v46, v46 row_shr:8 row_mask:0xf bank_mask:0xf
  v_max_f32_dpp v47, v47, v47 row_shr:8 row_mask:0xf bank_mask:0xf
  v_max_f32_dpp v44, v44, v44 row_bcast:15 row_mask:0xa bank_mask:0xf
  v_max_f32_dpp v45, v45, v45 row_bcast:15 row_mask:0xa bank_mask:0xf
  v_max_f32_dpp v46, v46, v46 row_bcast:15 row_mask:0xa bank_mask:0xf
  v_max_f32_dpp v47, v47, v47 row_bcast:15 row_mask:0xa bank_mask:0xf
  s_mov_b32 exec_lo, 0x80000000
  s_mov_b32 exec_hi, 0x80000000
  buffer_store_dword v44, v35, s[24:27], 0 offen
  buffer_store_dword v45, v35, s[24:27], 0 offen offset:256
  buffer_store_dword v46, v39, s[24:27], 0 offen
  buffer_store_dword v47, v39, s[24:27], 0 offen offset:256
  s_mov_b64 exec, -1
k1_kernel_next5:
  s_branch k1_done
k1_vpath:
.p2align 3
k1_kernel_loop6:
  s_barrier
  v_add_u32 v11, s45, v7
  v_add_u32 v12, s45, v8
  v_add_u32 v13, s45, v9
  v_add_u32 v14, s45, v10
  ds_read_b128 v[32:35], v11
  ds_read_b128 v[36:39], v12
  ds_read_b64_tr_b16 v[40:41], v13 offset:0
  ds_read_b64_tr_b16 v[42:43], v13 offset:1024
  ds_read_b64_tr_b16 v[44:45], v14 offset:0
  ds_read_b64_tr_b16 v[46:47], v14 offset:1024
  v_xor_b32 v4, 32, v11
  v_xor_b32 v5, 64, v11
  v_xor_b32 v6, 96, v11
  v_xor_b32 v15, 32, v12
  v_xor_b32 v16, 64, v12
  v_xor_b32 v17, 96, v12
  s_cmp_eq_u32 s44, 0
  s_cbranch_scc1 k1_pfin
k1_retV:
  v_mfma_f32_32x32x16_bf16 v[96:111], v[64:67], v[72:75], v[96:111]
  v_mfma_f32_32x32x16_bf16 v[112:127], v[64:67], v[76:79], v[112:127]
  v_mfma_f32_32x32x16_bf16 v[128:143], v[68:71], v[72:75], v[128:143]
  v_mfma_f32_32x32x16_bf16 v[144:159], v[68:71], v[76:79], v[144:159]
  ds_read_b128 v[48:51], v4
  ds_read_b128 v[52:55], v15
  ds_read_b64_tr_b16 v[56:57], v13 offset:4096
  ds_read_b64_tr_b16 v[58:59], v13 offset:5120
  ds_read_b64_tr_b16 v[60:61], v14 offset:4096
  ds_read_b64_tr_b16 v[62:63], v14 offset:5120
  v_mfma_f32_32x32x16_bf16 v[96:111], v[80:83], v[88:91], v[96:111]
  v_mfma_f32_32x32x16_bf16 v[112:127], v[80:83], v[92:95], v[112:127]
  v_mfma_f32_32x32x16_bf16 v[128:143], v[84:87], v[88:91], v[128:143]
  v_mfma_f32_32x32x16_bf16 v[144:159], v[84:87], v[92:95], v[144:159]
  ds_read_b128 v[64:67], v5
  ds_read_b128 v[68:71], v16
  ds_read_b64_tr_b16 v[72:73], v13 offset:8192
  ds_read_b64_tr_b16 v[74:75], v13 offset:9216
  ds_read_b64_tr_b16 v[76:77], v14 offset:8192
  ds_read_b64_tr_b16 v[78:79], v14 offset:9216
  s_cmp_lg_u32 s44, 2
  s_cbranch_scc1 k1_kernel_loop6z
  s_cmp_lg_u32 s38, 0
  s_cbranch_scc1 k1_kernel_loop6z
  s_mov_b64 exec, 1
  buffer_store_byte v19, v18, s[56:59], 0 offen sc1
  s_mov_b64 exec, -1
k1_kernel_loop6z:
  s_waitcnt lgkmcnt(12)
  v_mfma_f32_32x32x16_bf16 v[96:111], v[32:35], v[40:43], v[96:111]
  v_mfma_f32_32x32x16_bf16 v[112:127], v[32:35], v[44:47], v[112:127]
  v_mfma_f32_32x32x16_bf16 v[128:143], v[36:39], v[40:43], v[128:143]
  v_mfma_f32_32x32x16_bf16 v[144:159], v[36:39], v[44:47], v[144:159]
  ds_read_b128 v[80:83], v6
  ds_read_b128 v[84:87], v17
  ds_read_b64_tr_b16 v[88:89], v13 offset:12288
  ds_read_b64_tr_b16 v[90:91], v13 offset:13312
  ds_read_b64_tr_b16 v[92:93], v14 offset:12288
  ds_read_b64_tr_b16 v[94:95], v14 offset:13312
  s_waitcnt lgkmcnt(12)
  v_mfma_f32_32x32x16_bf16 v[96:111], v[48:51], v[56:59], v[96:111]
  v_mfma_f32_32x32x16_bf16 v[112:127], v[48:51], v[60:63], v[112:127]
  v_mfma_f32_32x32x16_bf16 v[128:143], v[52:55], v[56:59], v[128:143]
  v_mfma_f32_32x32x16_bf16 v[144:159], v[52:55], v[60:63], v[144:159]
  s_add_u32 s45, s45, 32768
  s_and_b32 s45, s45, 0x1ffff
  s_add_u32 s44, s44, 1
  s_cmp_lg_u32 s44, 2
  s_cbranch_scc1 k1_kernel_loop6y
  s_waitcnt vmcnt(0)
k1_kernel_loop6y:
  s_cmp_lt_u32 s44, 9
  s_waitcnt lgkmcnt(0)
  s_cbranch_scc1 k1_kernel_loop6
  v_mfma_f32_32x32x16_bf16 v[96:111], v[64:67], v[72:75], v[96:111]
  v_mfma_f32_32x32x16_bf16 v[112:127], v[64:67], v[76:79], v[112:127]
  v_mfma_f32_32x32x16_bf16 v[128:143], v[68:71], v[72:75], v[128:143]
  v_mfma_f32_32x32x16_bf16 v[144:159], v[68:71], v[76:79], v[144:159]
  v_mfma_f32_32x32x16_bf16 v[96:111], v[80:83], v[88:91], v[96:111]
  v_mfma_f32_32x32x16_bf16 v[112:127], v[80:83], v[92:95], v[112:127]
  v_mfma_f32_32x32x16_bf16 v[128:143], v[84:87], v[88:91], v[128:143]
  v_mfma_f32_32x32x16_bf16 v[144:159], v[84:87], v[92:95], v[144:159]
  s_barrier
  s_lshl_b32 s46, s61, 7
  v_lshl_add_u32 v27, v2, 2, s46
  ds_read_b32 v21, v27 offset:33792
  s_lshl_b32 s46, s62, 7
  v_lshl_add_u32 v27, v2, 2, s46
  ds_read_b32 v26, v27 offset:33792
  s_lshl_b32 s46, s38, 8
  v_lshl_add_u32 v30, v3, 5, s46
  v_xor_b32 v31, 256, v30
  s_lshl_b32 s63, s36, 2
  s_xor_b32 s64, s38, 1
  s_add_u32 s64, s64, s63
  s_add_u32 s63, s63, s38
  s_sub_u32 s65, s37, 11
  s_lshl_b32 s65, s65, 7
  v_mov_b32 v32, s47
  v_mov_b32 v33, s47
  v_mov_b32 v34, s47
  v_mov_b32 v35, s47
  ds_read_b128 v[160:163], v30 offset:32768
  ds_read_b128 v[164:167], v30 offset:32784
  ds_read_b128 v[168:171], v30 offset:32832
  ds_read_b128 v[172:175], v30 offset:32848
  ds_read_b128 v[176:179], v30 offset:32896
  ds_read_b128 v[180:183], v30 offset:32912
  ds_read_b128 v[184:187], v30 offset:32960
  ds_read_b128 v[188:191], v30 offset:32976
  s_lshl_b32 s66, s61, 5
  s_add_u32 s66, s66, s65
  v_add_u32 v24, s66, v2
  v_mul_u32_u24 v25, 3641, v24
  v_lshrrev_b32 v25, 16, v25
  v_mul_u32_u24 v28, 18, v25
  v_sub_u32 v24, v24, v28
  v_lshrrev_b32 v28, 2, v24
  v_mul_u32_u24 v28, 5, v28
  s_mov_b32 s46, 17966496
  v_bfe_u32 v28, s46, v28, 5
  v_and_b32 v29, 3, v24
  v_add_u32 v28, v28, v29
  s_mov_b32 s46, 151552
  v_mul_lo_u32 v25, v25, s46
  v_mul_u32_u24 v29, 304, v3
  v_add_u32 v25, v25, v29
  s_cmp_ge_u32 s66, 576
  s_cselect_b32 s46, 1073741824, 0
  v_add_u32 v25, s46, v25
  v_lshl_add_u32 v18, v28, 4, v25
  v_add_u32 v19, 128, v25
  v_cmp_eq_u32 vcc, 0, v24
  v_mov_b32 v29, 1073741824
  s_nop 0
  v_cndmask_b32 v19, v29, v19, vcc
  s_lshl_b32 s66, s62, 5
  s_add_u32 s66, s66, s65
  v_add_u32 v24, s66, v2
  v_mul_u32_u24 v25, 3641, v24
  v_lshrrev_b32 v25, 16, v25
  v_mul_u32_u24 v28, 18, v25
  v_sub_u32 v24, v24, v28
  v_lshrrev_b32 v28, 2, v24
  v_mul_u32_u24 v28, 5, v28
  s_mov_b32 s46, 17966496
  v_bfe_u32 v28, s46, v28, 5
  v_and_b32 v29, 3, v24
  v_add_u32 v28, v28, v29
  s_mov_b32 s46, 151552
  v_mul_lo_u32 v25, v25, s46
  v_mul_u32_u24 v29, 304, v3
  v_add_u32 v25, v25, v29
  s_cmp_ge_u32 s66, 576
  s_cselect_b32 s46, 1073741824, 0
  v_add_u32 v25, s46, v25
  v_lshl_add_u32 v20, v28, 4, v25
  v_add_u32 v27, 128, v25
  v_cmp_eq_u32 vcc, 0, v24
  v_mov_b32 v29, 1073741824
  s_nop 0
  v_cndmask_b32 v27, v29, v27, vcc
  s_lshr_b32 s70, s63, 1
  s_mul_i32 s70, s70, 4736
  s_and_b32 s71, s63, 1
  s_mul_i32 s71, s71, 1216
  s_add_u32 s70, s70, s71
  s_add_u32 s70, s70, 2048
  s_waitcnt lgkmcnt(0)
  v_fma_f32 v96, v21, v161, v96
  v_fma_f32 v97, v21, v163, v97
  v_fma_f32 v98, v21, v165, v98
  v_fma_f32 v99, v21, v167, v99
  v_fma_f32 v100, v21, v169, v100
  v_fma_f32 v101, v21, v171, v101
  v_fma_f32 v102, v21, v173, v102
  v_fma_f32 v103, v21, v175, v103
  v_fma_f32 v104, v21, v177, v104
  v_fma_f32 v105, v21, v179, v105
  v_fma_f32 v106, v21, v181, v106
  v_fma_f32 v107, v21, v183, v107
  v_fma_f32 v108, v21, v185, v108
  v_fma_f32 v109, v21, v187, v109
  v_fma_f32 v110, v21, v189, v110
  v_fma_f32 v111, v21, v191, v111
  v_mul_f32 v96, v96, v160
  v_mul_f32 v97, v97, v162
  v_mul_f32 v98, v98, v164
  v_mul_f32 v99, v99, v166
  v_mul_f32 v100, v100, v168
  v_mul_f32 v101, v101, v170
  v_mul_f32 v102, v102, v172
  v_mul_f32 v103, v103, v174
  v_mul_f32 v104, v104, v176
  v_mul_f32 v105, v105, v178
  v_mul_f32 v106, v106, v180
  v_mul_f32 v107, v107, v182
  v_mul_f32 v108, v108, v184
  v_mul_f32 v109, v109, v186
  v_mul_f32 v110, v110, v188
  v_mul_f32 v111, v111, v190
  v_fma_f32 v112, v26, v161, v112
  v_fma_f32 v113, v26, v163, v113
  v_fma_f32 v114, v26, v165, v114
  v_fma_f32 v115, v26, v167, v115
  v_fma_f32 v116, v26, v169, v116
  v_fma_f32 v117, v26, v171, v117
  v_fma_f32 v118, v26, v173, v118
  v_fma_f32 v119, v26, v175, v119
  v_fma_f32 v120, v26, v177, v120
  v_fma_f32 v121, v26, v179, v121
  v_fma_f32 v122, v26, v181, v122
  v_fma_f32 v123, v26, v183, v123
  v_fma_f32 v124, v26, v185, v124
  v_fma_f32 v125, v26, v187, v125
  v_fma_f32 v126, v26, v189, v126
  v_fma_f32 v127, v26, v191, v127
  v_mul_f32 v112, v112, v160
  v_mul_f32 v113, v113, v162
  v_mul_f32 v114, v114, v164
  v_mul_f32 v115, v115, v166
  v_mul_f32 v116, v116, v168
  v_mul_f32 v117, v117, v170
  v_mul_f32 v118, v118, v172
  v_mul_f32 v119, v119, v174
  v_mul_f32 v120, v120, v176
  v_mul_f32 v121, v121, v178
  v_mul_f32 v122, v122, v180
  v_mul_f32 v123, v123, v182
  v_mul_f32 v124, v124, v184
  v_mul_f32 v125, v125, v186
  v_mul_f32 v126, v126, v188
  v_mul_f32 v127, v127, v190
  ds_read_b128 v[160:163], v31 offset:32768
  ds_read_b128 v[164:167], v31 offset:32784
  ds_read_b128 v[168:171], v31 offset:32832
  ds_read_b128 v[172:175], v31 offset:32848
  ds_read_b128 v[176:179], v31 offset:32896
  ds_read_b128 v[180:183], v31 offset:32912
  ds_read_b128 v[184:187], v31 offset:32960
  ds_read_b128 v[188:191], v31 offset:32976
  v_cvt_pk_bf16_f32 v40, v96, v97
  v_cvt_pk_bf16_f32 v41, v98, v99
  v_cvt_pk_bf16_f32 v42, v100, v101
  v_cvt_pk_bf16_f32 v43, v102, v103
  v_cvt_pk_bf16_f32 v44, v104, v105
  v_cvt_pk_bf16_f32 v45, v106, v107
  v_cvt_pk_bf16_f32 v46, v108, v109
  v_cvt_pk_bf16_f32 v47, v110, v111
  buffer_store_dwordx4 v[40:43], v18, s[24:27], s70 offen
  buffer_store_dwordx4 v[44:47], v18, s[24:27], s70 offen offset:608
  buffer_store_dwordx4 v[32:35], v19, s[24:27], s70 offen
  buffer_store_dwordx4 v[32:35], v19, s[24:27], s70 offen offset:608
  v_cvt_pk_bf16_f32 v48, v112, v113
  v_cvt_pk_bf16_f32 v49, v114, v115
  v_cvt_pk_bf16_f32 v50, v116, v117
  v_cvt_pk_bf16_f32 v51, v118, v119
  v_cvt_pk_bf16_f32 v52, v120, v121
  v_cvt_pk_bf16_f32 v53, v122, v123
  v_cvt_pk_bf16_f32 v54, v124, v125
  v_cvt_pk_bf16_f32 v55, v126, v127
  buffer_store_dwordx4 v[48:51], v20, s[24:27], s70 offen
  buffer_store_dwordx4 v[52:55], v20, s[24:27], s70 offen offset:608
  buffer_store_dwordx4 v[32:35], v27, s[24:27], s70 offen
  buffer_store_dwordx4 v[32:35], v27, s[24:27], s70 offen offset:608
  s_lshr_b32 s70, s64, 1
  s_mul_i32 s70, s70, 4736
  s_and_b32 s71, s64, 1
  s_mul_i32 s71, s71, 1216
  s_add_u32 s70, s70, s71
  s_add_u32 s70, s70, 2048
  s_waitcnt lgkmcnt(0)
  v_fma_f32 v128, v21, v161, v128
  v_fma_f32 v129, v21, v163, v129
  v_fma_f32 v130, v21, v165, v130
  v_fma_f32 v131, v21, v167, v131
  v_fma_f32 v132, v21, v169, v132
  v_fma_f32 v133, v21, v171, v133
  v_fma_f32 v134, v21, v173, v134
  v_fma_f32 v135, v21, v175, v135
  v_fma_f32 v136, v21, v177, v136
  v_fma_f32 v137, v21, v179, v137
  v_fma_f32 v138, v21, v181, v138
  v_fma_f32 v139, v21, v183, v139
  v_fma_f32 v140, v21, v185, v140
  v_fma_f32 v141, v21, v187, v141
  v_fma_f32 v142, v21, v189, v142
  v_fma_f32 v143, v21, v191, v143
  v_mul_f32 v128, v128, v160
  v_mul_f32 v129, v129, v162
  v_mul_f32 v130, v130, v164
  v_mul_f32 v131, v131, v166
  v_mul_f32 v132, v132, v168
  v_mul_f32 v133, v133, v170
  v_mul_f32 v134, v134, v172
  v_mul_f32 v135, v135, v174
  v_mul_f32 v136, v136, v176
  v_mul_f32 v137, v137, v178
  v_mul_f32 v138, v138, v180
  v_mul_f32 v139, v139, v182
  v_mul_f32 v140, v140, v184
  v_mul_f32 v141, v141, v186
  v_mul_f32 v142, v142, v188
  v_mul_f32 v143, v143, v190
  v_fma_f32 v144, v26, v161, v144
  v_fma_f32 v145, v26, v163, v145
  v_fma_f32 v146, v26, v165, v146
  v_fma_f32 v147, v26, v167, v147
  v_fma_f32 v148, v26, v169, v148
  v_fma_f32 v149, v26, v171, v149
  v_fma_f32 v150, v26, v173, v150
  v_fma_f32 v151, v26, v175, v151
  v_fma_f32 v152, v26, v177, v152
  v_fma_f32 v153, v26, v179, v153
  v_fma_f32 v154, v26, v181, v154
  v_fma_f32 v155, v26, v183, v155
  v_fma_f32 v156, v26, v185, v156
  v_fma_f32 v157, v26, v187, v157
  v_fma_f32 v158, v26, v189, v158
  v_fma_f32 v159, v26, v191, v159
  v_mul_f32 v144, v144, v160
  v_mul_f32 v145, v145, v162
  v_mul_f32 v146, v146, v164
  v_mul_f32 v147, v147, v166
  v_mul_f32 v148, v148, v168
  v_mul_f32 v149, v149, v170
  v_mul_f32 v150, v150, v172
  v_mul_f32 v151, v151, v174
  v_mul_f32 v152, v152, v176
  v_mul_f32 v153, v153, v178
  v_mul_f32 v154, v154, v180
  v_mul_f32 v155, v155, v182
  v_mul_f32 v156, v156, v184
  v_mul_f32 v157, v157, v186
  v_mul_f32 v158, v158, v188
  v_mul_f32 v159, v159, v190
  v_cvt_pk_bf16_f32 v40, v128, v129
  v_cvt_pk_bf16_f32 v41, v130, v131
  v_cvt_pk_bf16_f32 v42, v132, v133
  v_cvt_pk_bf16_f32 v43, v134, v135
  v_cvt_pk_bf16_f32 v44, v136, v137
  v_cvt_pk_bf16_f32 v45, v138, v139
  v_cvt_pk_bf16_f32 v46, v140, v141
  v_cvt_pk_bf16_f32 v47, v142, v143
  buffer_store_dwordx4 v[40:43], v18, s[24:27], s70 offen
  buffer_store_dwordx4 v[44:47], v18, s[24:27], s70 offen offset:608
  buffer_store_dwordx4 v[32:35], v19, s[24:27], s70 offen
  buffer_store_dwordx4 v[32:35], v19, s[24:27], s70 offen offset:608
  v_cvt_pk_bf16_f32 v48, v144, v145
  v_cvt_pk_bf16_f32 v49, v146, v147
  v_cvt_pk_bf16_f32 v50, v148, v149
  v_cvt_pk_bf16_f32 v51, v150, v151
  v_cvt_pk_bf16_f32 v52, v152, v153
  v_cvt_pk_bf16_f32 v53, v154, v155
  v_cvt_pk_bf16_f32 v54, v156, v157
  v_cvt_pk_bf16_f32 v55, v158, v159
  buffer_store_dwordx4 v[48:51], v20, s[24:27], s70 offen
  buffer_store_dwordx4 v[52:55], v20, s[24:27], s70 offen offset:608
  buffer_store_dwordx4 v[32:35], v27, s[24:27], s70 offen
  buffer_store_dwordx4 v[32:35], v27, s[24:27], s70 offen offset:608
k1_done:
k1_end:
  s_endpgm
.globl k2_kernel
.p2align 8
.type k2_kernel,@function
k2_kernel:
  s_cmp_ge_u32 s2, 256
  s_cbranch_scc1 k2_end
  s_load_dwordx2 s[4:5], s[0:1], 80
  s_load_dwordx4 s[52:55], s[0:1], 40
  s_load_dwordx2 s[56:57], s[0:1], 56
  s_load_dwordx2 s[58:59], s[0:1], 0
  v_and_b32 v1, 63, v0
  v_lshrrev_b32 v11, 6, v0
  v_and_b32 v2, 31, v0
  v_readfirstlane_b32 s14, v11
  v_bfe_u32 v3, v0, 5, 1
  v_lshlrev_b32 v4, 4, v1
  s_and_b32 s12, s2, 7
  s_lshl_b32 s12, s12, 2
  s_bfe_u32 s16, s2, 0x20003
  s_add_u32 s12, s12, s16
  s_lshr_b32 s13, s2, 5
  s_lshl_b32 s15, s13, 3
  s_add_u32 s15, s15, s14
  s_mul_i32 s16, s12, 151552
  s_lshl_b32 s17, s12, 6
  s_add_u32 s17, s17, s15
  s_lshl_b32 s18, s17, 10
  s_add_u32 s18, s18, 5242880
  s_lshl_b32 s19, s17, 7
  s_add_u32 s19, s19, 7340032
  s_lshl_b32 s20, s12, 8
  s_add_u32 s20, s20, 7602176
  v_lshlrev_b32 v11, 2, v2
  v_lshlrev_b32 v12, 2, v1
  s_lshl_b32 s21, s14, 10
  s_add_u32 s22, s16, s21
  s_waitcnt lgkmcnt(0)
  s_mov_b32 s8, s4
  s_and_b32 s9, s5, 0xffff
  s_mov_b32 s10, 16777216
  s_mov_b32 s11, 0x20000
  s_mov_b32 m0, s21
  s_add_u32 s21, s21, 8192
  buffer_load_dwordx4 v4, s[8:11], s22 offen lds
  s_add_u32 s22, s22, 8192
  buffer_load_dwordx4 v[16:19], v4, s[8:11], s18 offen
  buffer_load_dword v20, v11, s[8:11], s19 offen
  buffer_load_dword v13, v12, s[8:11], s20 offen
  s_add_u32 s20, s20, 8192
  buffer_load_dword v14, v12, s[8:11], s20 offen
  s_mov_b32 m0, s21
  s_add_u32 s21, s21, 8192
  buffer_load_dwordx4 v4, s[8:11], s22 offen lds
  s_add_u32 s22, s22, 8192
  s_mov_b32 m0, s21
  s_add_u32 s21, s21, 8192
  buffer_load_dwordx4 v4, s[8:11], s22 offen lds
  s_add_u32 s22, s22, 8192
  v_lshrrev_b32 v11, 2, v2
  v_mul_u32_u24 v11, 5, v11
  s_mov_b32 s23, 17970464
  v_bfe_u32 v11, s23, v11, 5
  v_and_b32 v15, 3, v2
  v_add_u32 v11, v11, v15
  v_cmp_lt_u32 s[28:29], 17, v2
  v_mov_b32 v23, 0x3f803f80
  v_mul_u32_u24 v15, 304, v3
  v_cndmask_b32 v11, v11, 8, s[28:29]
  v_lshl_add_u32 v9, v11, 4, v15
  v_add_u32 v9, 2048, v9
  v_and_b32 v15, 27, v2
  v_cmp_lt_u32 s[28:29], 18, v15
  v_cmp_eq_u32 s[30:31], 16, v15
  v_cmp_eq_u32 s[32:33], 17, v15
  v_cmp_lt_u32 s[34:35], 19, v2
  s_or_b64 s[30:31], s[30:31], s[32:33]
  s_and_b64 s[30:31], s[30:31], s[34:35]
  s_or_b64 s[28:29], s[28:29], s[30:31]
  v_mov_b32 v15, 0x40000
  v_cndmask_b32 v9, v9, v15, s[28:29]
  v_mov_b32 v8, v4
  v_add_u32 v10, 4480, v12
  v_mov_b32 v15, 0
  s_waitcnt vmcnt(2)
  v_add_f32 v13, v13, v14
  v_dot2_f32_bf16 v15, v16, v16, v15
  v_dot2_f32_bf16 v15, v17, v17, v15
  v_max_f32_dpp v13, v13, v13 row_shr:1 row_mask:0xf bank_mask:0xf
  v_dot2_f32_bf16 v15, v18, v18, v15
  v_dot2_f32_bf16 v15, v19, v19, v15
  v_max_f32_dpp v13, v13, v13 row_shr:2 row_mask:0xf bank_mask:0xf
  s_nop 1
  v_max_f32_dpp v13, v13, v13 row_shr:4 row_mask:0xf bank_mask:0xf
  v_mov_b32 v14, v15
  s_nop 0
  v_max_f32_dpp v13, v13, v13 row_shr:8 row_mask:0xf bank_mask:0xf
  v_permlane32_swap_b32 v14, v15
  s_nop 0
  v_max_f32_dpp v13, v13, v13 row_bcast:15 row_mask:0xa bank_mask:0xf
  v_add_f32 v15, v14, v15
  v_dot2_f32_bf16 v15, v20, v20, v15
  v_max_f32_dpp v13, v13, v13 row_bcast:31 row_mask:0xc bank_mask:0xf
  s_nop 1
  v_readlane_b32 s24, v13, 63
  s_nop 1
  v_mul_f32 v15, s24, v15
  v_sqrt_f32 v15, v15
  s_mov_b32 s26, 0
  v_mul_f32 v15, 0xbf828f5c, v15
  v_cvt_pk_bf16_f32 v21, v15, 0
  s_waitcnt vmcnt(0)
  s_barrier
  s_mov_b32 s27, 0
  s_lshr_b32 s36, s14, 2
k2_main:
  v_mov_b32 v5, v8
  v_mov_b32 v6, v9
  v_mov_b32 v7, v10
  ds_read_b32 v22, v7 offset:0
  ds_read_b128 v[24:27], v5 offset:0
  ds_read_b128 v[28:31], v5 offset:1024
  v_mov_b32 v64, 0
  v_mov_b32 v65, 0
  v_mov_b32 v66, 0
  v_mov_b32 v67, 0
  v_mov_b32 v68, 0
  v_mov_b32 v69, 0
  v_mov_b32 v70, 0
  v_mov_b32 v71, 0
  v_mov_b32 v72, 0
  v_mov_b32 v73, 0
  v_mov_b32 v74, 0
  v_mov_b32 v75, 0
  v_mov_b32 v76, 0
  v_mov_b32 v77, 0
  v_mov_b32 v78, 0
  v_mov_b32 v79, 0
  v_mov_b32 v60, 0
  v_mov_b32 v61, 0
  v_mov_b32 v62, 0
  v_mov_b32 v63, 0
  v_mov_b32 v44, 0
  v_mov_b32 v45, 0
  v_mov_b32 v46, 0
  v_mov_b32 v47, 0
  s_waitcnt lgkmcnt(2)
  v_mfma_f32_32x32x4_2b_bf16 v[80:111], v[22:23], v[20:21], 0
  ds_read_b32 v22, v7 offset:4736
  ds_read_b128 v[32:35], v6 offset:0
  s_nop 15
  s_nop 1
  s_waitcnt lgkmcnt(2)
  v_mfma_f32_32x32x16_bf16 v[80:95], v[24:27], v[16:19], v[80:95]
  ds_read_b128 v[24:27], v5 offset:4736
  ds_read_b128 v[36:39], v6 offset:608
  v_mfma_f32_32x32x16_bf16 v[96:111], v[28:31], v[16:19], v[96:111]
  ds_read_b128 v[28:31], v5 offset:5760
  ds_read_b128 v[40:43], v6 offset:1216
  s_mov_b32 s25, s26
  s_nop 4
  s_waitcnt lgkmcnt(5)
.p2align 3
k2_loop:
  s_cmp_eq_u32 s25, 10
  s_cbranch_scc1 k2_pf
  s_cmp_gt_u32 s25, 9
  s_cbranch_scc1 k2_body
  s_bitcmp0_b32 s25, 0
  s_cbranch_scc1 k2_nodma
  s_waitcnt vmcnt(0)
  s_barrier
k2_nodma:
  s_cmp_gt_u32 s25, 7
  s_cbranch_scc1 k2_body
  s_mov_b32 m0, s21
  s_add_u32 s21, s21, 8192
  buffer_load_dwordx4 v4, s[8:11], s22 offen lds
  s_add_u32 s22, s22, 8192
  s_mov_b32 m0, s21
  s_add_u32 s21, s21, 8192
  buffer_load_dwordx4 v4, s[8:11], s22 offen lds
  s_add_u32 s22, s22, 8192
k2_body:
  s_xor_b32 s36, s36, 1
  s_cmp_eq_u32 s36, 1
  s_cbranch_scc1 k2_p1
  s_setprio 0
  s_branch k2_p2
k2_p1:
  s_setprio 1
k2_p2:
  s_waitcnt lgkmcnt(6)
  s_nop 0
  v_mfma_f32_32x32x16_bf16 v[64:79], v[44:47], v[60:63], v[64:79]
  ds_read_b128 v[44:47], v6 offset:1824
  v_exp_f32 v80, v80
  v_exp_f32 v81, v81
  v_exp_f32 v82, v82
  v_exp_f32 v83, v83
  v_cvt_pk_bf16_f32 v48, v80, v81
  s_waitcnt lgkmcnt(6)
  v_mfma_f32_32x32x4_2b_bf16 v[112:143], v[22:23], v[20:21], 0
  ds_read_b32 v22, v7 offset:9472
  v_exp_f32 v84, v84
  v_exp_f32 v85, v85
  v_cvt_pk_bf16_f32 v49, v82, v83
  v_exp_f32 v86, v86
  v_exp_f32 v87, v87
  v_cvt_pk_bf16_f32 v50, v84, v85
  v_cvt_pk_bf16_f32 v51, v86, v87
  v_exp_f32 v88, v88
  v_exp_f32 v89, v89
  s_waitcnt lgkmcnt(6)
  v_mfma_f32_32x32x16_bf16 v[64:79], v[32:35], v[48:51], v[64:79]
  ds_read_b128 v[32:35], v6 offset:4736
  v_exp_f32 v90, v90
  v_exp_f32 v91, v91
  v_cvt_pk_bf16_f32 v52, v88, v89
  v_exp_f32 v92, v92
  v_exp_f32 v93, v93
  v_cvt_pk_bf16_f32 v53, v90, v91
  v_exp_f32 v94, v94
  v_exp_f32 v95, v95
  s_waitcnt lgkmcnt(6)
  v_mfma_f32_32x32x16_bf16 v[112:127], v[24:27], v[16:19], v[112:127]
  ds_read_b128 v[24:27], v5 offset:9472
  v_cvt_pk_bf16_f32 v54, v92, v93
  v_cvt_pk_bf16_f32 v55, v94, v95
  v_exp_f32 v96, v96
  v_exp_f32 v97, v97
  v_exp_f32 v98, v98
  s_waitcnt lgkmcnt(6)
  v_mfma_f32_32x32x16_bf16 v[64:79], v[36:39], v[52:55], v[64:79]
  ds_read_b128 v[36:39], v6 offset:5344
  v_exp_f32 v99, v99
  v_cvt_pk_bf16_f32 v56, v96, v97
  v_exp_f32 v100, v100
  v_exp_f32 v101, v101
  v_cvt_pk_bf16_f32 v57, v98, v99
  s_waitcnt lgkmcnt(6)
  v_mfma_f32_32x32x16_bf16 v[128:143], v[28:31], v[16:19], v[128:143]
  ds_read_b128 v[28:31], v5 offset:10496
  v_exp_f32 v102, v102
  v_exp_f32 v103, v103
  v_cvt_pk_bf16_f32 v58, v100, v101
  v_cvt_pk_bf16_f32 v59, v102, v103
  v_exp_f32 v104, v104
  v_exp_f32 v105, v105
  s_waitcnt lgkmcnt(6)
  v_mfma_f32_32x32x16_bf16 v[64:79], v[40:43], v[56:59], v[64:79]
  ds_read_b128 v[40:43], v6 offset:5952
  v_exp_f32 v106, v106
  v_exp_f32 v107, v107
  v_cvt_pk_bf16_f32 v60, v104, v105
  v_exp_f32 v108, v108
  v_exp_f32 v109, v109
  v_cvt_pk_bf16_f32 v61, v106, v107
  v_exp_f32 v110, v110
  v_exp_f32 v111, v111
  v_cvt_pk_bf16_f32 v62, v108, v109
  v_cvt_pk_bf16_f32 v63, v110, v111
  s_waitcnt lgkmcnt(6)
  s_nop 0
  v_mfma_f32_32x32x16_bf16 v[64:79], v[44:47], v[60:63], v[64:79]
  ds_read_b128 v[44:47], v6 offset:6560
  v_exp_f32 v112, v112
  v_exp_f32 v113, v113
  v_exp_f32 v114, v114
  v_exp_f32 v115, v115
  v_cvt_pk_bf16_f32 v48, v112, v113
  s_waitcnt lgkmcnt(6)
  v_mfma_f32_32x32x4_2b_bf16 v[80:111], v[22:23], v[20:21], 0
  ds_read_b32 v22, v7 offset:14208
  v_exp_f32 v116, v116
  v_exp_f32 v117, v117
  v_cvt_pk_bf16_f32 v49, v114, v115
  v_exp_f32 v118, v118
  v_exp_f32 v119, v119
  v_cvt_pk_bf16_f32 v50, v116, v117
  v_cvt_pk_bf16_f32 v51, v118, v119
  v_exp_f32 v120, v120
  v_exp_f32 v121, v121
  s_waitcnt lgkmcnt(6)
  v_mfma_f32_32x32x16_bf16 v[64:79], v[32:35], v[48:51], v[64:79]
  ds_read_b128 v[32:35], v6 offset:9472
  v_exp_f32 v122, v122
  v_exp_f32 v123, v123
  v_cvt_pk_bf16_f32 v52, v120, v121
  v_exp_f32 v124, v124
  v_exp_f32 v125, v125
  v_cvt_pk_bf16_f32 v53, v122, v123
  v_exp_f32 v126, v126
  v_exp_f32 v127, v127
  s_waitcnt lgkmcnt(6)
  v_mfma_f32_32x32x16_bf16 v[80:95], v[24:27], v[16:19], v[80:95]
  ds_read_b128 v[24:27], v5 offset:14208
  v_cvt_pk_bf16_f32 v54, v124, v125
  v_cvt_pk_bf16_f32 v55, v126, v127
  v_exp_f32 v128, v128
  v_exp_f32 v129, v129
  v_exp_f32 v130, v130
  s_waitcnt lgkmcnt(6)
  v_mfma_f32_32x32x16_bf16 v[64:79], v[36:39], v[52:55], v[64:79]
  ds_read_b128 v[36:39], v6 offset:10080
  v_exp_f32 v131, v131
  v_cvt_pk_bf16_f32 v56, v128, v129
  v_exp_f32 v132, v132
  v_exp_f32 v133, v133
  v_cvt_pk_bf16_f32 v57, v130, v131
  s_waitcnt lgkmcnt(6)
  v_mfma_f32_32x32x16_bf16 v[96:111], v[28:31], v[16:19], v[96:111]
  ds_read_b128 v[28:31], v5 offset:15232
  v_exp_f32 v134, v134
  v_exp_f32 v135, v135
  v_cvt_pk_bf16_f32 v58, v132, v133
  v_cvt_pk_bf16_f32 v59, v134, v135
  v_exp_f32 v136, v136
  v_exp_f32 v137, v137
  s_waitcnt lgkmcnt(6)
  v_mfma_f32_32x32x16_bf16 v[64:79], v[40:43], v[56:59], v[64:79]
  ds_read_b128 v[40:43], v6 offset:10688
  v_exp_f32 v138, v138
  v_exp_f32 v139, v139
  v_cvt_pk_bf16_f32 v60, v136, v137
  v_exp_f32 v140, v140
  v_exp_f32 v141, v141
  v_cvt_pk_bf16_f32 v61, v138, v139
  v_exp_f32 v142, v142
  v_exp_f32 v143, v143
  v_cvt_pk_bf16_f32 v62, v140, v141
  v_cvt_pk_bf16_f32 v63, v142, v143
  v_add_u32 v5, 9472, v5
  v_add_u32 v6, 9472, v6
  v_add_u32 v7, 9472, v7
  s_add_u32 s25, s25, 1
  s_add_u32 s27, s27, 1
  s_cmp_lt_u32 s27, 16
  s_cbranch_scc1 k2_loop
  s_waitcnt lgkmcnt(0)
  v_mfma_f32_32x32x16_bf16 v[64:79], v[44:47], v[60:63], v[64:79]
  s_nop 15
  v_cmp_nle_f32 vcc, 0x12800000, v74
  s_cmp_lg_u32 s26, 0
  s_cbranch_scc1 k2_ok
  s_cbranch_vccz k2_ok
  v_mov_b32 v21, 0
  v_mov_b32 v11, 0xff800000
  v_mov_b32 v5, v8
  v_mov_b32 v7, v10
  s_mov_b32 s27, 0
k2_fbloop:
  ds_read_b32 v22, v7 offset:0
  ds_read_b128 v[24:27], v5 offset:0
  ds_read_b128 v[28:31], v5 offset:1024
  s_waitcnt lgkmcnt(0)
  v_mfma_f32_32x32x4_2b_bf16 v[80:111], v[22:23], v[20:21], 0
  s_nop 15
  s_nop 3
  v_mfma_f32_32x32x16_bf16 v[80:95], v[24:27], v[16:19], v[80:95]
  v_mfma_f32_32x32x16_bf16 v[96:111], v[28:31], v[16:19], v[96:111]
  v_add_u32 v5, 4736, v5
  v_add_u32 v7, 4736, v7
  s_nop 15
  v_max3_f32 v11, v80, v81, v11
  v_max3_f32 v11, v82, v83, v11
  v_max3_f32 v11, v84, v85, v11
  v_max3_f32 v11, v86, v87, v11
  v_max3_f32 v11, v88, v89, v11
  v_max3_f32 v11, v90, v91, v11
  v_max3_f32 v11, v92, v93, v11
  v_max3_f32 v11, v94, v95, v11
  v_max3_f32 v11, v96, v97, v11
  v_max3_f32 v11, v98, v99, v11
  v_max3_f32 v11, v100, v101, v11
  v_max3_f32 v11, v102, v103, v11
  v_max3_f32 v11, v104, v105, v11
  v_max3_f32 v11, v106, v107, v11
  v_max3_f32 v11, v108, v109, v11
  v_max3_f32 v11, v110, v111, v11
  s_add_u32 s27, s27, 1
  s_cmp_lt_u32 s27, 32
  s_cbranch_scc1 k2_fbloop
  v_mov_b32 v12, v11
  s_nop 1
  v_permlane32_swap_b32 v11, v12
  v_max_f32 v11, v11, v12
  v_sub_f32 v11, 0, v11
  v_cvt_pk_bf16_f32 v12, v11, v11
  v_and_b32 v12, 0xffff0000, v12
  v_sub_f32 v13, v11, v12
  v_cvt_pk_bf16_f32 v21, v12, v13
  s_mov_b32 s26, 11
  s_mov_b32 s27, 0
  s_branch k2_main
k2_pf:
  v_mul_u32_u24 v11, 405, v0
  v_lshrrev_b32 v11, 16, v11
  v_mul_u32_u24 v12, 162, v11
  v_sub_u32 v12, v0, v12
  v_mul_u32_u24 v13, 7282, v12
  v_lshrrev_b32 v13, 16, v13
  v_mul_u32_u24 v14, 9, v13
  v_sub_u32 v12, v12, v14
  s_lshr_b32 s34, s2, 3
  s_mul_i32 s34, s34, 18
  v_add_u32 v13, s34, v13
  s_and_b32 s35, s2, 7
  s_mul_i32 s34, s35, 1152
  s_mul_i32 s35, s35, 663552
  v_mul_u32_u24 v14, 9216, v13
  v_add_u32 v14, s34, v14
  v_mul_u32_u24 v15, 1152, v13
  v_add_u32 v15, s35, v15
  v_lshl_add_u32 v14, v12, 7, v14
  v_lshl_add_u32 v15, v12, 7, v15
  v_cmp_eq_u32 s[34:35], 0, v11
  v_cmp_eq_u32 s[36:37], 1, v11
  v_cmp_eq_u32 s[38:39], 2, v11
  s_nop 0
  s_mov_b64 exec, s[34:35]
  s_cbranch_execz k2_pf1
  global_load_dword v144, v14, s[52:53]
k2_pf1:
  s_mov_b64 exec, s[36:37]
  s_cbranch_execz k2_pf2
  global_load_dword v144, v14, s[54:55]
k2_pf2:
  s_mov_b64 exec, s[38:39]
  s_cbranch_execz k2_pf3
  global_load_dword v144, v15, s[56:57]
k2_pf3:
  s_mov_b64 exec, -1
  s_lshr_b32 s34, s2, 3
  s_mul_i32 s35, s34, 20736
  s_add_u32 s35, s35, 11010048
  v_lshlrev_b32 v11, 7, v0
  s_movk_i32 s36, 162
  v_cmp_gt_u32 s[38:39], s36, v0
  v_subrev_u32 v12, 162, v0
  s_mul_i32 s34, s34, 72
  v_add_u32 v13, s34, v12
  v_mul_u32_u24 v14, 1821, v13
  v_lshrrev_b32 v14, 20, v14
  v_mul_u32_u24 v15, 576, v14
  v_sub_u32 v13, v13, v15
  s_and_b32 s34, s2, 7
  v_lshl_add_u32 v14, v14, 3, s34
  s_mov_b32 s34, 73728
  v_mul_lo_u32 v14, v14, s34
  v_lshl_add_u32 v14, v13, 7, v14
  s_movk_i32 s36, 72
  v_cmp_gt_u32 s[36:37], s36, v12
  s_mov_b64 exec, s[38:39]
  s_cbranch_execz k2_pf5
  buffer_load_dword v144, v11, s[8:11], s35 offen
k2_pf5:
  s_mov_b64 exec, s[36:37]
  s_cbranch_execz k2_pf6
  global_load_dword v144, v14, s[58:59]
k2_pf6:
  s_mov_b64 exec, -1
  s_cmp_lg_u32 s14, 7
  s_cbranch_scc1 k2_pf4
  s_getpc_b64 s[28:29]
  s_add_u32 s28, s28, k3_kernel-.
  s_addc_u32 s29, s29, 0
  v_lshlrev_b32 v11, 7, v1
  global_load_dword v144, v11, s[28:29]
  v_add_u32 v11, 8192, v11
  s_bfm_b64 exec, (k34_end-k3_kernel-8192+127)>>7, 0
  global_load_dword v144, v11, s[28:29]
  s_mov_b64 exec, -1
k2_pf4:
  s_lshr_b32 s36, s14, 2
  s_and_b32 s37, s25, 1
  s_xor_b32 s36, s36, s37
  s_branch k2_body
k2_ok:
  v_rcp_f32 v11, v74
  s_mul_i32 s18, s15, 36
  s_add_u32 s19, s18, s12
  s_lshl_b32 s19, s19, 10
  s_add_u32 s19, s19, 8388608
  s_lshr_b32 s20, s12, 3
  s_add_u32 s18, s18, s20
  s_add_u32 s18, s18, 32
  s_lshl_b32 s18, s18, 10
  s_bfe_u32 s20, s12, 0x10002
  s_lshl_b32 s20, s20, 9
  s_add_u32 s18, s18, s20
  s_and_b32 s20, s12, 3
  s_lshl_b32 s20, s20, 2
  s_add_u32 s18, s18, s20
  s_add_u32 s18, s18, 8388608
  v_mul_f32 v64, v64, v11
  v_mul_f32 v65, v65, v11
  v_mul_f32 v66, v66, v11
  v_mul_f32 v67, v67, v11
  v_mul_f32 v68, v68, v11
  v_mul_f32 v69, v69, v11
  v_mul_f32 v70, v70, v11
  v_mul_f32 v71, v71, v11
  v_mul_f32 v72, v72, v11
  v_mul_f32 v73, v73, v11
  v_cvt_pk_bf16_f32 v48, v64, v65
  v_cvt_pk_bf16_f32 v49, v66, v67
  v_cvt_pk_bf16_f32 v50, v68, v69
  v_cvt_pk_bf16_f32 v51, v70, v71
  v_cvt_pk_bf16_f32 v52, v72, v73
  buffer_store_dwordx4 v[48:51], v4, s[8:11], s19 offen
  s_mov_b32 exec_hi, 0
  buffer_store_dword v52, v4, s[8:11], s18 offen
k2_end:
  s_endpgm
.globl k3_kernel
.p2align 8
.type k3_kernel,@function
k3_kernel:
  s_cmp_ge_u32 s2, 512
  s_cbranch_scc1 k34_end
  s_load_dwordx2 s[4:5], s[0:1], 80
  v_lshrrev_b32 v5, 6, v0
  v_and_b32 v1, 63, v0
  v_readfirstlane_b32 s22, v5
  s_waitcnt lgkmcnt(0)
  s_mov_b32 s8, s4
  s_and_b32 s9, s5, 0xffff
  s_mov_b32 s10, 16777216
  s_mov_b32 s11, 0x20000
  s_cmp_ge_u32 s2, 256
  s_cbranch_scc1 k34_p2
  s_setprio 2
  s_load_dwordx2 s[6:7], s[0:1], 0
  s_load_dwordx2 s[20:21], s[0:1], 32
  v_and_b32 v2, 31, v0
  v_bfe_u32 v3, v0, 5, 1
  v_lshlrev_b32 v4, 4, v1
  s_and_b32 s23, s2, 31
  s_lshr_b32 s24, s2, 5
  s_mul_i32 s25, s23, 73728
  s_mul_i32 s26, s22, 9216
  s_add_u32 s25, s25, s26
  s_add_u32 s25, s25, 8388608
  s_mul_i32 s27, s24, 73728
  s_add_u32 s27, s27, s26
  s_add_u32 s27, s27, 11010048
  s_add_u32 s28, s25, 36864
  s_add_u32 s29, s27, 36864
  s_bfe_u32 s40, s24, 0x10001
  s_add_u32 s40, s40, 16
  s_mul_i32 s41, s40, 36864
  s_add_u32 s41, s41, s26
  s_add_u32 s41, s41, 11010048
  s_and_b32 s42, s24, 1
  s_lshr_b32 s43, s24, 2
  s_cmp_eq_u32 s42, 1
  s_cselect_b32 s44, s28, s25
  s_cselect_b32 s28, s25, s28
  s_mov_b32 s25, s44
  buffer_load_dwordx4 v[32:35], v4, s[8:11], s25 offen offset:0
  buffer_load_dwordx4 v[40:43], v4, s[8:11], s27 offen offset:0
  buffer_load_dwordx4 v[36:39], v4, s[8:11], s28 offen offset:0
  buffer_load_dwordx4 v[44:47], v4, s[8:11], s29 offen offset:0
  buffer_load_dwordx4 v[48:51], v4, s[8:11], s41 offen offset:0
  buffer_load_dwordx4 v[52:55], v4, s[8:11], s25 offen offset:1024
  buffer_load_dwordx4 v[60:63], v4, s[8:11], s27 offen offset:1024
  buffer_load_dwordx4 v[56:59], v4, s[8:11], s28 offen offset:1024
  buffer_load_dwordx4 v[64:67], v4, s[8:11], s29 offen offset:1024
  buffer_load_dwordx4 v[68:71], v4, s[8:11], s41 offen offset:1024
  buffer_load_dwordx4 v[72:75], v4, s[8:11], s25 offen offset:2048
  buffer_load_dwordx4 v[80:83], v4, s[8:11], s27 offen offset:2048
  buffer_load_dwordx4 v[76:79], v4, s[8:11], s28 offen offset:2048
  buffer_load_dwordx4 v[84:87], v4, s[8:11], s29 offen offset:2048
  buffer_load_dwordx4 v[88:91], v4, s[8:11], s41 offen offset:2048
  buffer_load_dwordx4 v[92:95], v4, s[8:11], s25 offen offset:3072
  buffer_load_dwordx4 v[100:103], v4, s[8:11], s27 offen offset:3072
  buffer_load_dwordx4 v[96:99], v4, s[8:11], s28 offen offset:3072
  buffer_load_dwordx4 v[104:107], v4, s[8:11], s29 offen offset:3072
  buffer_load_dwordx4 v[108:111], v4, s[8:11], s41 offen offset:3072
  s_add_u32 s25, s25, 4096
  s_add_u32 s27, s27, 4096
  s_add_u32 s28, s28, 4096
  s_add_u32 s29, s29, 4096
  s_add_u32 s41, s41, 4096
  buffer_load_dwordx4 v[112:115], v4, s[8:11], s25 offen offset:0
  buffer_load_dwordx4 v[120:123], v4, s[8:11], s27 offen offset:0
  buffer_load_dwordx4 v[116:119], v4, s[8:11], s28 offen offset:0
  buffer_load_dwordx4 v[124:127], v4, s[8:11], s29 offen offset:0
  buffer_load_dwordx4 v[128:131], v4, s[8:11], s41 offen offset:0
  buffer_load_dwordx4 v[132:135], v4, s[8:11], s25 offen offset:1024
  buffer_load_dwordx4 v[140:143], v4, s[8:11], s27 offen offset:1024
  buffer_load_dwordx4 v[136:139], v4, s[8:11], s28 offen offset:1024
  buffer_load_dwordx4 v[144:147], v4, s[8:11], s29 offen offset:1024
  buffer_load_dwordx4 v[148:151], v4, s[8:11], s41 offen offset:1024
  buffer_load_dwordx4 v[152:155], v4, s[8:11], s25 offen offset:2048
  buffer_load_dwordx4 v[160:163], v4, s[8:11], s27 offen offset:2048
  buffer_load_dwordx4 v[156:159], v4, s[8:11], s28 offen offset:2048
  buffer_load_dwordx4 v[164:167], v4, s[8:11], s29 offen offset:2048
  buffer_load_dwordx4 v[168:171], v4, s[8:11], s41 offen offset:2048
  s_waitcnt lgkmcnt(0)
  s_mov_b32 s12, s6
  s_and_b32 s13, s7, 0xffff
  s_mov_b32 s14, 2359296
  s_mov_b32 s15, 0x20000
  s_mov_b32 s16, s20
  s_and_b32 s17, s21, 0xffff
  s_mov_b32 s18, 1152
  s_mov_b32 s19, 0x20000
  v_and_b32 v7, 15, v2
  v_lshlrev_b32 v5, 1, v3
  v_xor_b32 v5, v5, v7
  v_lshlrev_b32 v5, 4, v5
  v_lshl_add_u32 v5, v2, 8, v5
  s_lshl_b32 s36, s22, 14
  v_add_u32 v5, s36, v5
  v_lshlrev_b32 v30, 6, v2
  v_lshl_add_u32 v30, v3, 5, v30
  s_lshl_b32 s36, s22, 11
  v_add_u32 v30, s36, v30
  v_lshrrev_b32 v2, 2, v1
  v_and_b32 v3, 3, v1
  v_lshlrev_b32 v6, 2, v3
  v_xor_b32 v6, v6, v2
  v_lshlrev_b32 v6, 4, v6
  v_lshl_add_u32 v6, v2, 8, v6
  s_lshl_b32 s36, s22, 12
  v_add_u32 v6, s36, v6
  v_mul_u32_u24 v7, 1152, v2
  v_lshl_add_u32 v29, v3, 3, v7
  v_lshl_add_u32 v7, v3, 5, v7
  v_lshlrev_b32 v31, 5, v3
  v_lshlrev_b32 v28, 3, v3
  s_lshr_b32 s30, s22, 1
  s_xor_b32 s31, s30, s42
  s_lshl_b32 s32, s23, 1
  s_add_u32 s32, s32, s31
  s_lshl_b32 s32, s32, 5
  s_and_b32 s31, s22, 1
  s_lshl_b32 s31, s31, 4
  s_add_u32 s32, s32, s31
  s_mul_i32 s34, s32, 1152
  s_lshl_b32 s35, s24, 7
  s_lshl_b32 s47, s40, 6
  s_lshl_b32 s46, s43, 5
  s_add_u32 s47, s47, s46
  s_cmp_eq_u32 s30, 0
  s_cselect_b32 s47, s47, 1073741824
  s_add_u32 s46, s34, s47
  s_add_u32 s34, s34, s35
  s_waitcnt vmcnt(30)
  v_mfma_f32_32x32x16_bf16 v[172:187], v[40:43], v[32:35], 0
  v_mfma_f32_32x32x16_bf16 v[188:203], v[44:47], v[32:35], 0
  v_mfma_f32_32x32x16_bf16 v[204:219], v[40:43], v[36:39], 0
  v_mfma_f32_32x32x16_bf16 v[220:235], v[44:47], v[36:39], 0
  v_mfma_f32_32x32x16_bf16 v[236:251], v[48:51], v[32:35], 0
  buffer_load_dwordx4 v[32:35], v4, s[8:11], s25 offen offset:3072
  buffer_load_dwordx4 v[40:43], v4, s[8:11], s27 offen offset:3072
  buffer_load_dwordx4 v[36:39], v4, s[8:11], s28 offen offset:3072
  buffer_load_dwordx4 v[44:47], v4, s[8:11], s29 offen offset:3072
  buffer_load_dwordx4 v[48:51], v4, s[8:11], s41 offen offset:3072
  s_waitcnt vmcnt(30)
  v_mfma_f32_32x32x16_bf16 v[172:187], v[60:63], v[52:55], v[172:187]
  v_mfma_f32_32x32x16_bf16 v[188:203], v[64:67], v[52:55], v[188:203]
  v_mfma_f32_32x32x16_bf16 v[204:219], v[60:63], v[56:59], v[204:219]
  v_mfma_f32_32x32x16_bf16 v[220:235], v[64:67], v[56:59], v[220:235]
  v_mfma_f32_32x32x16_bf16 v[236:251], v[68:71], v[52:55], v[236:251]
  s_add_u32 s25, s25, 4096
  s_add_u32 s27, s27, 4096
  s_add_u32 s28, s28, 4096
  s_add_u32 s29, s29, 4096
  s_add_u32 s41, s41, 4096
  buffer_load_dwordx4 v[52:55], v4, s[8:11], s25 offen offset:0
  buffer_load_dwordx4 v[60:63], v4, s[8:11], s27 offen offset:0
  buffer_load_dwordx4 v[56:59], v4, s[8:11], s28 offen offset:0
  buffer_load_dwordx4 v[64:67], v4, s[8:11], s29 offen offset:0
  buffer_load_dwordx4 v[68:71], v4, s[8:11], s41 offen offset:0
  buffer_load_dwordx4 v[8:11], v7, s[12:15], s34 offen
  buffer_load_dwordx4 v[12:15], v7, s[12:15], s34 offen offset:16
  buffer_load_dwordx4 v[16:19], v31, s[16:19], s35 offen
  buffer_load_dwordx4 v[20:23], v31, s[16:19], s35 offen offset:16
  buffer_load_dwordx2 v[24:25], v29, s[12:15], s46 offen
  buffer_load_dwordx2 v[26:27], v28, s[16:19], s47 offen
  s_waitcnt vmcnt(36)
  v_mfma_f32_32x32x16_bf16 v[172:187], v[80:83], v[72:75], v[172:187]
  v_mfma_f32_32x32x16_bf16 v[188:203], v[84:87], v[72:75], v[188:203]
  v_mfma_f32_32x32x16_bf16 v[204:219], v[80:83], v[76:79], v[204:219]
  v_mfma_f32_32x32x16_bf16 v[220:235], v[84:87], v[76:79], v[220:235]
  v_mfma_f32_32x32x16_bf16 v[236:251], v[88:91], v[72:75], v[236:251]
  s_waitcnt vmcnt(31)
  v_mfma_f32_32x32x16_bf16 v[172:187], v[100:103], v[92:95], v[172:187]
  v_mfma_f32_32x32x16_bf16 v[188:203], v[104:107], v[92:95], v[188:203]
  v_mfma_f32_32x32x16_bf16 v[204:219], v[100:103], v[96:99], v[204:219]
  v_mfma_f32_32x32x16_bf16 v[220:235], v[104:107], v[96:99], v[220:235]
  v_mfma_f32_32x32x16_bf16 v[236:251], v[108:111], v[92:95], v[236:251]
  s_waitcnt vmcnt(26)
  v_mfma_f32_32x32x16_bf16 v[172:187], v[120:123], v[112:115], v[172:187]
  v_mfma_f32_32x32x16_bf16 v[188:203], v[124:127], v[112:115], v[188:203]
  v_mfma_f32_32x32x16_bf16 v[204:219], v[120:123], v[116:119], v[204:219]
  v_mfma_f32_32x32x16_bf16 v[220:235], v[124:127], v[116:119], v[220:235]
  v_mfma_f32_32x32x16_bf16 v[236:251], v[128:131], v[112:115], v[236:251]
  s_waitcnt vmcnt(21)
  v_mfma_f32_32x32x16_bf16 v[172:187], v[140:143], v[132:135], v[172:187]
  v_mfma_f32_32x32x16_bf16 v[188:203], v[144:147], v[132:135], v[188:203]
  v_mfma_f32_32x32x16_bf16 v[204:219], v[140:143], v[136:139], v[204:219]
  v_mfma_f32_32x32x16_bf16 v[220:235], v[144:147], v[136:139], v[220:235]
  v_mfma_f32_32x32x16_bf16 v[236:251], v[148:151], v[132:135], v[236:251]
  s_waitcnt vmcnt(16)
  v_mfma_f32_32x32x16_bf16 v[172:187], v[160:163], v[152:155], v[172:187]
  v_mfma_f32_32x32x16_bf16 v[188:203], v[164:167], v[152:155], v[188:203]
  v_mfma_f32_32x32x16_bf16 v[204:219], v[160:163], v[156:159], v[204:219]
  v_mfma_f32_32x32x16_bf16 v[220:235], v[164:167], v[156:159], v[220:235]
  v_mfma_f32_32x32x16_bf16 v[236:251], v[168:171], v[152:155], v[236:251]
  s_waitcnt vmcnt(11)
  v_mfma_f32_32x32x16_bf16 v[172:187], v[40:43], v[32:35], v[172:187]
  v_mfma_f32_32x32x16_bf16 v[188:203], v[44:47], v[32:35], v[188:203]
  v_mfma_f32_32x32x16_bf16 v[204:219], v[40:43], v[36:39], v[204:219]
  v_mfma_f32_32x32x16_bf16 v[220:235], v[44:47], v[36:39], v[220:235]
  v_mfma_f32_32x32x16_bf16 v[236:251], v[48:51], v[32:35], v[236:251]
  s_waitcnt vmcnt(6)
  v_mfma_f32_32x32x16_bf16 v[172:187], v[60:63], v[52:55], v[172:187]
  v_mfma_f32_32x32x16_bf16 v[188:203], v[64:67], v[52:55], v[188:203]
  v_mfma_f32_32x32x16_bf16 v[204:219], v[60:63], v[56:59], v[204:219]
  v_mfma_f32_32x32x16_bf16 v[220:235], v[64:67], v[56:59], v[220:235]
  v_mfma_f32_32x32x16_bf16 v[236:251], v[68:71], v[52:55], v[236:251]
  v_xor_b32 v32, 16, v5
  v_xor_b32 v33, 64, v5
  v_xor_b32 v34, 80, v5
  v_xor_b32 v35, 128, v5
  v_xor_b32 v36, 144, v5
  v_xor_b32 v37, 192, v5
  v_xor_b32 v38, 208, v5
  s_nop 4
  ds_write_b128 v5, v[172:175] offset:0
  ds_write_b128 v32, v[176:179] offset:0
  ds_write_b128 v33, v[180:183] offset:0
  ds_write_b128 v34, v[184:187] offset:0
  ds_write_b128 v35, v[188:191] offset:0
  ds_write_b128 v36, v[192:195] offset:0
  ds_write_b128 v37, v[196:199] offset:0
  ds_write_b128 v38, v[200:203] offset:0
  ds_write_b128 v5, v[204:207] offset:8192
  ds_write_b128 v32, v[208:211] offset:8192
  ds_write_b128 v33, v[212:215] offset:8192
  ds_write_b128 v34, v[216:219] offset:8192
  ds_write_b128 v35, v[220:223] offset:8192
  ds_write_b128 v36, v[224:227] offset:8192
  ds_write_b128 v37, v[228:231] offset:8192
  ds_write_b128 v38, v[232:235] offset:8192
  v_add_u32 v30, 0x10000, v30
  s_cmp_eq_u32 s43, 0
  s_cbranch_scc1 k3_e0
  ds_write_b128 v30, v[244:247]
  ds_write_b128 v30, v[248:251] offset:16
  s_branch k3_e1
k3_e0:
  ds_write_b128 v30, v[236:239]
  ds_write_b128 v30, v[240:243] offset:16
k3_e1:
  v_xor_b32 v32, 16, v6
  v_xor_b32 v33, 32, v6
  v_xor_b32 v34, 48, v6
  s_and_b32 s36, s22, 1
  s_lshl_b32 s36, s36, 10
  s_add_u32 s36, s36, 0x10000
  v_lshlrev_b32 v35, 4, v1
  v_add_u32 v35, s36, v35
  s_waitcnt vmcnt(0)
  v_lshlrev_b32 v160, 16, v8
  v_and_b32 v161, 0xffff0000, v8
  v_lshlrev_b32 v180, 16, v16
  v_and_b32 v181, 0xffff0000, v16
  v_lshlrev_b32 v162, 16, v9
  v_and_b32 v163, 0xffff0000, v9
  v_lshlrev_b32 v182, 16, v17
  v_and_b32 v183, 0xffff0000, v17
  v_lshlrev_b32 v164, 16, v10
  v_and_b32 v165, 0xffff0000, v10
  v_lshlrev_b32 v184, 16, v18
  v_and_b32 v185, 0xffff0000, v18
  v_lshlrev_b32 v166, 16, v11
  v_and_b32 v167, 0xffff0000, v11
  v_lshlrev_b32 v186, 16, v19
  v_and_b32 v187, 0xffff0000, v19
  v_lshlrev_b32 v168, 16, v12
  v_and_b32 v169, 0xffff0000, v12
  v_lshlrev_b32 v188, 16, v20
  v_and_b32 v189, 0xffff0000, v20
  v_lshlrev_b32 v170, 16, v13
  v_and_b32 v171, 0xffff0000, v13
  v_lshlrev_b32 v190, 16, v21
  v_and_b32 v191, 0xffff0000, v21
  v_lshlrev_b32 v172, 16, v14
  v_and_b32 v173, 0xffff0000, v14
  v_lshlrev_b32 v192, 16, v22
  v_and_b32 v193, 0xffff0000, v22
  v_lshlrev_b32 v174, 16, v15
  v_and_b32 v175, 0xffff0000, v15
  v_lshlrev_b32 v194, 16, v23
  v_and_b32 v195, 0xffff0000, v23
  v_lshlrev_b32 v176, 16, v24
  v_and_b32 v177, 0xffff0000, v24
  v_lshlrev_b32 v196, 16, v26
  v_and_b32 v197, 0xffff0000, v26
  v_lshlrev_b32 v178, 16, v25
  v_and_b32 v179, 0xffff0000, v25
  v_lshlrev_b32 v198, 16, v27
  v_and_b32 v199, 0xffff0000, v27
  s_waitcnt lgkmcnt(0)
  s_barrier
  ds_read_b128 v[64:67], v6 offset:0
  ds_read_b128 v[68:71], v32 offset:0
  ds_read_b128 v[72:75], v33 offset:0
  ds_read_b128 v[76:79], v34 offset:0
  ds_read_b128 v[80:83], v35 offset:0
  ds_read_b128 v[84:87], v6 offset:16384
  ds_read_b128 v[88:91], v32 offset:16384
  ds_read_b128 v[92:95], v33 offset:16384
  ds_read_b128 v[96:99], v34 offset:16384
  ds_read_b128 v[100:103], v35 offset:2048
  ds_read_b128 v[104:107], v6 offset:32768
  ds_read_b128 v[108:111], v32 offset:32768
  ds_read_b128 v[112:115], v33 offset:32768
  ds_read_b128 v[116:119], v34 offset:32768
  ds_read_b128 v[120:123], v35 offset:4096
  ds_read_b128 v[124:127], v6 offset:49152
  ds_read_b128 v[128:131], v32 offset:49152
  ds_read_b128 v[132:135], v33 offset:49152
  ds_read_b128 v[136:139], v34 offset:49152
  ds_read_b128 v[140:143], v35 offset:6144
  s_waitcnt lgkmcnt(10)
  v_pk_add_f32 v[64:65], v[64:65], v[84:85]
  v_pk_add_f32 v[66:67], v[66:67], v[86:87]
  v_pk_add_f32 v[68:69], v[68:69], v[88:89]
  v_pk_add_f32 v[70:71], v[70:71], v[90:91]
  v_pk_add_f32 v[72:73], v[72:73], v[92:93]
  v_pk_add_f32 v[74:75], v[74:75], v[94:95]
  v_pk_add_f32 v[76:77], v[76:77], v[96:97]
  v_pk_add_f32 v[78:79], v[78:79], v[98:99]
  v_pk_add_f32 v[80:81], v[80:81], v[100:101]
  v_pk_add_f32 v[82:83], v[82:83], v[102:103]
  s_waitcnt lgkmcnt(0)
  v_pk_add_f32 v[104:105], v[104:105], v[124:125]
  v_pk_add_f32 v[106:107], v[106:107], v[126:127]
  v_pk_add_f32 v[108:109], v[108:109], v[128:129]
  v_pk_add_f32 v[110:111], v[110:111], v[130:131]
  v_pk_add_f32 v[112:113], v[112:113], v[132:133]
  v_pk_add_f32 v[114:115], v[114:115], v[134:135]
  v_pk_add_f32 v[116:117], v[116:117], v[136:137]
  v_pk_add_f32 v[118:119], v[118:119], v[138:139]
  v_pk_add_f32 v[120:121], v[120:121], v[140:141]
  v_pk_add_f32 v[122:123], v[122:123], v[142:143]
  v_pk_add_f32 v[64:65], v[64:65], v[104:105]
  v_pk_add_f32 v[66:67], v[66:67], v[106:107]
  v_pk_add_f32 v[68:69], v[68:69], v[108:109]
  v_pk_add_f32 v[70:71], v[70:71], v[110:111]
  v_pk_add_f32 v[72:73], v[72:73], v[112:113]
  v_pk_add_f32 v[74:75], v[74:75], v[114:115]
  v_pk_add_f32 v[76:77], v[76:77], v[116:117]
  v_pk_add_f32 v[78:79], v[78:79], v[118:119]
  v_pk_add_f32 v[80:81], v[80:81], v[120:121]
  v_pk_add_f32 v[82:83], v[82:83], v[122:123]
  v_cvt_pk_bf16_f32 v144, v64, v65
  v_cvt_pk_bf16_f32 v145, v66, v67
  v_cvt_pk_bf16_f32 v146, v68, v69
  v_cvt_pk_bf16_f32 v147, v70, v71
  v_cvt_pk_bf16_f32 v148, v72, v73
  v_cvt_pk_bf16_f32 v149, v74, v75
  v_cvt_pk_bf16_f32 v150, v76, v77
  v_cvt_pk_bf16_f32 v151, v78, v79
  v_cvt_pk_bf16_f32 v152, v80, v81
  v_cvt_pk_bf16_f32 v153, v82, v83
  v_lshlrev_b32 v64, 16, v144
  v_and_b32 v65, 0xffff0000, v144
  v_lshlrev_b32 v66, 16, v145
  v_and_b32 v67, 0xffff0000, v145
  v_lshlrev_b32 v68, 16, v146
  v_and_b32 v69, 0xffff0000, v146
  v_lshlrev_b32 v70, 16, v147
  v_and_b32 v71, 0xffff0000, v147
  v_lshlrev_b32 v72, 16, v148
  v_and_b32 v73, 0xffff0000, v148
  v_lshlrev_b32 v74, 16, v149
  v_and_b32 v75, 0xffff0000, v149
  v_lshlrev_b32 v76, 16, v150
  v_and_b32 v77, 0xffff0000, v150
  v_lshlrev_b32 v78, 16, v151
  v_and_b32 v79, 0xffff0000, v151
  v_lshlrev_b32 v80, 16, v152
  v_and_b32 v81, 0xffff0000, v152
  v_lshlrev_b32 v82, 16, v153
  v_and_b32 v83, 0xffff0000, v153
  v_pk_add_f32 v[64:65], v[64:65], v[160:161]
  v_pk_add_f32 v[66:67], v[66:67], v[162:163]
  v_pk_add_f32 v[68:69], v[68:69], v[164:165]
  v_pk_add_f32 v[70:71], v[70:71], v[166:167]
  v_pk_add_f32 v[72:73], v[72:73], v[168:169]
  v_pk_add_f32 v[74:75], v[74:75], v[170:171]
  v_pk_add_f32 v[76:77], v[76:77], v[172:173]
  v_pk_add_f32 v[78:79], v[78:79], v[174:175]
  v_pk_add_f32 v[80:81], v[80:81], v[176:177]
  v_pk_add_f32 v[82:83], v[82:83], v[178:179]
  v_cvt_pk_bf16_f32 v144, v64, v65
  v_cvt_pk_bf16_f32 v145, v66, v67
  v_cvt_pk_bf16_f32 v146, v68, v69
  v_cvt_pk_bf16_f32 v147, v70, v71
  v_cvt_pk_bf16_f32 v148, v72, v73
  v_cvt_pk_bf16_f32 v149, v74, v75
  v_cvt_pk_bf16_f32 v150, v76, v77
  v_cvt_pk_bf16_f32 v151, v78, v79
  v_cvt_pk_bf16_f32 v152, v80, v81
  v_cvt_pk_bf16_f32 v153, v82, v83
  s_add_u32 s34, s34, 12582912
  s_add_u32 s46, s46, 12582912
  buffer_store_dwordx4 v[144:147], v7, s[8:11], s34 offen sc1
  buffer_store_dwordx4 v[148:151], v7, s[8:11], s34 offen offset:16 sc1
  buffer_store_dwordx2 v[152:153], v29, s[8:11], s46 offen sc1
  s_cmp_eq_u32 s30, 0
  s_cselect_b32 s36, -1, 0
  v_lshlrev_b32 v64, 16, v144
  v_and_b32 v65, 0xffff0000, v144
  v_lshlrev_b32 v66, 16, v145
  v_and_b32 v67, 0xffff0000, v145
  v_lshlrev_b32 v68, 16, v146
  v_and_b32 v69, 0xffff0000, v146
  v_lshlrev_b32 v70, 16, v147
  v_and_b32 v71, 0xffff0000, v147
  v_lshlrev_b32 v72, 16, v148
  v_and_b32 v73, 0xffff0000, v148
  v_lshlrev_b32 v74, 16, v149
  v_and_b32 v75, 0xffff0000, v149
  v_lshlrev_b32 v76, 16, v150
  v_and_b32 v77, 0xffff0000, v150
  v_lshlrev_b32 v78, 16, v151
  v_and_b32 v79, 0xffff0000, v151
  v_lshlrev_b32 v80, 16, v152
  v_and_b32 v81, 0xffff0000, v152
  v_lshlrev_b32 v82, 16, v153
  v_and_b32 v83, 0xffff0000, v153
  v_and_b32 v80, s36, v80
  v_and_b32 v81, s36, v81
  v_and_b32 v82, s36, v82
  v_and_b32 v83, s36, v83
  v_pk_add_f32 v[100:101], v[64:65], v[66:67]
  v_pk_mul_f32 v[102:103], v[64:65], v[64:65]
  v_pk_mul_f32 v[104:105], v[64:65], v[180:181]
  v_pk_fma_f32 v[102:103], v[66:67], v[66:67], v[102:103]
  v_pk_fma_f32 v[104:105], v[66:67], v[182:183], v[104:105]
  v_pk_add_f32 v[100:101], v[100:101], v[68:69]
  v_pk_fma_f32 v[102:103], v[68:69], v[68:69], v[102:103]
  v_pk_fma_f32 v[104:105], v[68:69], v[184:185], v[104:105]
  v_pk_add_f32 v[100:101], v[100:101], v[70:71]
  v_pk_fma_f32 v[102:103], v[70:71], v[70:71], v[102:103]
  v_pk_fma_f32 v[104:105], v[70:71], v[186:187], v[104:105]
  v_pk_add_f32 v[100:101], v[100:101], v[72:73]
  v_pk_fma_f32 v[102:103], v[72:73], v[72:73], v[102:103]
  v_pk_fma_f32 v[104:105], v[72:73], v[188:189], v[104:105]
  v_pk_add_f32 v[100:101], v[100:101], v[74:75]
  v_pk_fma_f32 v[102:103], v[74:75], v[74:75], v[102:103]
  v_pk_fma_f32 v[104:105], v[74:75], v[190:191], v[104:105]
  v_pk_add_f32 v[100:101], v[100:101], v[76:77]
  v_pk_fma_f32 v[102:103], v[76:77], v[76:77], v[102:103]
  v_pk_fma_f32 v[104:105], v[76:77], v[192:193], v[104:105]
  v_pk_add_f32 v[100:101], v[100:101], v[78:79]
  v_pk_fma_f32 v[102:103], v[78:79], v[78:79], v[102:103]
  v_pk_fma_f32 v[104:105], v[78:79], v[194:195], v[104:105]
  v_pk_add_f32 v[100:101], v[100:101], v[80:81]
  v_pk_fma_f32 v[102:103], v[80:81], v[80:81], v[102:103]
  v_pk_fma_f32 v[104:105], v[80:81], v[196:197], v[104:105]
  v_pk_add_f32 v[100:101], v[100:101], v[82:83]
  v_pk_fma_f32 v[102:103], v[82:83], v[82:83], v[102:103]
  v_pk_fma_f32 v[104:105], v[82:83], v[198:199], v[104:105]
  v_add_f32 v100, v100, v101
  v_add_f32 v102, v102, v103
  v_add_f32 v104, v104, v105
  s_lshl_b32 s36, s32, 2
  s_add_u32 s36, s36, 15204352
  v_add_f32_dpp v100, v100, v100 quad_perm:[1,0,3,2] row_mask:0xf bank_mask:0xf
  v_add_f32_dpp v102, v102, v102 quad_perm:[1,0,3,2] row_mask:0xf bank_mask:0xf
  v_add_f32_dpp v104, v104, v104 quad_perm:[1,0,3,2] row_mask:0xf bank_mask:0xf
  v_cmp_eq_u32 s[48:49], 1, v3
  v_add_f32_dpp v100, v100, v100 quad_perm:[2,3,0,1] row_mask:0xf bank_mask:0xf
  v_add_f32_dpp v102, v102, v102 quad_perm:[2,3,0,1] row_mask:0xf bank_mask:0xf
  v_add_f32_dpp v104, v104, v104 quad_perm:[2,3,0,1] row_mask:0xf bank_mask:0xf
  v_cmp_eq_u32 s[50:51], 2, v3
  v_cmp_gt_u32 s[52:53], 3, v3
  v_lshlrev_b32 v32, 2, v2
  v_lshl_add_u32 v32, v3, 13, v32
  v_cndmask_b32 v100, v100, v102, s[48:49]
  v_cndmask_b32 v100, v100, v104, s[50:51]
  s_mov_b64 exec, s[52:53]
  buffer_atomic_add_f32 v100, v32, s[8:11], s36 offen
  s_mov_b64 exec, -1
k3_noextra:
  s_bfe_u32 s36, s2, 0x30003
  s_lshl_b32 s36, s36, 7
  s_add_u32 s36, s36, 15247488
  v_lshlrev_b32 v7, 10, v1
  v_mov_b32 v6, 1
  s_waitcnt vmcnt(0)
  s_barrier
  s_cmp_lg_u32 s22, 0
  s_cbranch_scc1 k34_end
  s_mov_b64 exec, 0xff
  buffer_atomic_add v6, v7, s[8:11], s36 offen
  s_endpgm
k34_p2:
  s_load_dwordx4 s[32:35], s[0:1], 40
  s_load_dwordx4 s[36:39], s[0:1], 56
  s_sub_u32 s23, s2, 256
  v_lshlrev_b32 v3, 4, v0
  v_lshlrev_b32 v4, 4, v1
  v_cmp_gt_u32 s[40:41], 8, v1
  v_add_u32 v5, 1024, v4
  v_mov_b32 v6, 1073741824
  s_add_u32 s46, s4, 15257600
  s_addc_u32 s47, s5, 0
  s_load_dword s48, s[46:47], 0
  v_cndmask_b32 v5, v6, v5, s[40:41]
  s_mov_b32 s42, 72
  v_cmp_gt_u32 s[40:41], s42, v0
  s_waitcnt lgkmcnt(0)
  s_nop 0
  v_cndmask_b32 v15, v6, v3, s[40:41]
  s_mov_b32 s12, s32
  s_and_b32 s13, s33, 0xffff
  s_mov_b32 s14, 5308416
  s_mov_b32 s15, 0x20000
  s_mov_b32 s16, s34
  s_and_b32 s17, s35, 0xffff
  s_mov_b32 s18, 5308416
  s_mov_b32 s19, 0x20000
  s_mov_b32 s24, s36
  s_and_b32 s25, s37, 0xffff
  s_mov_b32 s26, 5308416
  s_mov_b32 s27, 0x20000
  s_mov_b32 s28, s38
  s_and_b32 s29, s39, 0xffff
  s_mov_b32 s30, 2359296
  s_mov_b32 s31, 0x20000
  s_cmp_ge_u32 s23, 144
  s_cbranch_scc1 p2_nodma
  v_mul_u32_u24 v7, 911, v0
  v_lshrrev_b32 v7, 16, v7
  v_mul_u32_u24 v8, 72, v7
  v_sub_u32 v8, v0, v8
  v_mul_u32_u24 v9, 1152, v7
  v_lshl_add_u32 v9, v8, 4, v9
  s_mov_b32 s42, 216
  v_cmp_gt_u32 s[40:41], s42, v0
  s_and_b32 s59, s23, 7
  s_mul_i32 s59, s59, 18
  s_lshr_b32 s52, s23, 3
  s_add_u32 s59, s59, s52
  s_mul_i32 s52, s59, 36864
  s_nop 0
  v_cndmask_b32 v9, v6, v9, s[40:41]
  buffer_load_dwordx4 v[72:75], v9, s[24:27], s52 offen
  s_add_u32 s52, s52, 3456
  buffer_load_dwordx4 v[76:79], v9, s[24:27], s52 offen
  s_add_u32 s52, s52, 3456
  buffer_load_dwordx4 v[80:83], v9, s[24:27], s52 offen
  s_add_u32 s52, s52, 3456
  buffer_load_dwordx4 v[84:87], v9, s[24:27], s52 offen
  s_add_u32 s52, s52, 3456
  buffer_load_dwordx4 v[88:91], v9, s[24:27], s52 offen
  s_add_u32 s52, s52, 3456
  buffer_load_dwordx4 v[92:95], v9, s[24:27], s52 offen
  s_add_u32 s52, s52, 3456
  buffer_load_dwordx4 v[96:99], v9, s[24:27], s52 offen
  s_add_u32 s52, s52, 3456
  buffer_load_dwordx4 v[100:103], v9, s[24:27], s52 offen
  s_add_u32 s52, s52, 3456
  buffer_load_dwordx4 v[104:107], v9, s[24:27], s52 offen
  s_add_u32 s52, s52, 3456
  buffer_load_dwordx4 v[108:111], v9, s[24:27], s52 offen
  s_add_u32 s52, s52, 3456
  buffer_load_dwordx4 v[112:115], v9, s[24:27], s52 offen
  v_lshrrev_b32 v6, 2, v1
  v_mul_u32_u24 v6, 9216, v6
  v_and_b32 v10, 3, v1
  v_lshl_add_u32 v6, v10, 4, v6
  s_sub_u32 s53, s22, 2
  s_mul_i32 s50, s53, 147456
  s_lshl_b32 s51, s59, 6
  s_add_u32 s50, s50, s51
  s_lshl_b32 s51, s53, 10
  s_mov_b32 s53, 0
  s_waitcnt vmcnt(0)
  v_lshlrev_b32 v152, 16, v72
  v_and_b32 v153, 0xffff0000, v72
  v_lshlrev_b32 v154, 16, v73
  v_and_b32 v155, 0xffff0000, v73
  v_lshlrev_b32 v156, 16, v74
  v_and_b32 v157, 0xffff0000, v74
  v_lshlrev_b32 v158, 16, v75
  v_and_b32 v159, 0xffff0000, v75
  v_lshlrev_b32 v160, 16, v76
  v_and_b32 v161, 0xffff0000, v76
  v_lshlrev_b32 v162, 16, v77
  v_and_b32 v163, 0xffff0000, v77
  v_lshlrev_b32 v164, 16, v78
  v_and_b32 v165, 0xffff0000, v78
  v_lshlrev_b32 v166, 16, v79
  v_and_b32 v167, 0xffff0000, v79
  v_lshlrev_b32 v168, 16, v80
  v_and_b32 v169, 0xffff0000, v80
  v_lshlrev_b32 v170, 16, v81
  v_and_b32 v171, 0xffff0000, v81
  v_lshlrev_b32 v172, 16, v82
  v_and_b32 v173, 0xffff0000, v82
  v_lshlrev_b32 v174, 16, v83
  v_and_b32 v175, 0xffff0000, v83
  v_lshlrev_b32 v176, 16, v84
  v_and_b32 v177, 0xffff0000, v84
  v_lshlrev_b32 v178, 16, v85
  v_and_b32 v179, 0xffff0000, v85
  v_lshlrev_b32 v180, 16, v86
  v_and_b32 v181, 0xffff0000, v86
  v_lshlrev_b32 v182, 16, v87
  v_and_b32 v183, 0xffff0000, v87
  v_lshlrev_b32 v184, 16, v88
  v_and_b32 v185, 0xffff0000, v88
  v_lshlrev_b32 v186, 16, v89
  v_and_b32 v187, 0xffff0000, v89
  v_lshlrev_b32 v188, 16, v90
  v_and_b32 v189, 0xffff0000, v90
  v_lshlrev_b32 v190, 16, v91
  v_and_b32 v191, 0xffff0000, v91
  v_lshlrev_b32 v192, 16, v92
  v_and_b32 v193, 0xffff0000, v92
  v_lshlrev_b32 v194, 16, v93
  v_and_b32 v195, 0xffff0000, v93
  v_lshlrev_b32 v196, 16, v94
  v_and_b32 v197, 0xffff0000, v94
  v_lshlrev_b32 v198, 16, v95
  v_and_b32 v199, 0xffff0000, v95
  v_lshlrev_b32 v200, 16, v96
  v_and_b32 v201, 0xffff0000, v96
  v_lshlrev_b32 v202, 16, v97
  v_and_b32 v203, 0xffff0000, v97
  v_lshlrev_b32 v204, 16, v98
  v_and_b32 v205, 0xffff0000, v98
  v_lshlrev_b32 v206, 16, v99
  v_and_b32 v207, 0xffff0000, v99
  v_lshlrev_b32 v208, 16, v100
  v_and_b32 v209, 0xffff0000, v100
  v_lshlrev_b32 v210, 16, v101
  v_and_b32 v211, 0xffff0000, v101
  v_lshlrev_b32 v212, 16, v102
  v_and_b32 v213, 0xffff0000, v102
  v_lshlrev_b32 v214, 16, v103
  v_and_b32 v215, 0xffff0000, v103
  v_lshlrev_b32 v216, 16, v104
  v_and_b32 v217, 0xffff0000, v104
  v_lshlrev_b32 v218, 16, v105
  v_and_b32 v219, 0xffff0000, v105
  v_lshlrev_b32 v220, 16, v106
  v_and_b32 v221, 0xffff0000, v106
  v_lshlrev_b32 v222, 16, v107
  v_and_b32 v223, 0xffff0000, v107
  v_lshlrev_b32 v224, 16, v108
  v_and_b32 v225, 0xffff0000, v108
  v_lshlrev_b32 v226, 16, v109
  v_and_b32 v227, 0xffff0000, v109
  v_lshlrev_b32 v228, 16, v110
  v_and_b32 v229, 0xffff0000, v110
  v_lshlrev_b32 v230, 16, v111
  v_and_b32 v231, 0xffff0000, v111
  v_lshlrev_b32 v232, 16, v112
  v_and_b32 v233, 0xffff0000, v112
  v_lshlrev_b32 v234, 16, v113
  v_and_b32 v235, 0xffff0000, v113
  v_lshlrev_b32 v236, 16, v114
  v_and_b32 v237, 0xffff0000, v114
  v_lshlrev_b32 v238, 16, v115
  v_and_b32 v239, 0xffff0000, v115
p2_nodma:
  s_cmp_lg_u32 s22, 0
  s_cbranch_scc1 p2_polledb
  v_lshlrev_b32 v10, 7, v1
  s_and_b32 s49, s23, 7
  s_lshl_b32 s49, s49, 10
  s_add_u32 s49, s49, 15247488
  s_mov_b32 s54, 0
  s_mov_b64 exec, 0xff
p2_pollb:
  buffer_load_dword v11, v10, s[8:11], s49 offen sc1
  s_waitcnt vmcnt(0)
  v_cmp_gt_u32 vcc, 32, v11
  s_add_u32 s54, s54, 1
  s_cmp_gt_u32 s54, 0x100000
  s_cbranch_vccz p2_pdoneb
  s_cbranch_scc1 p2_pdoneb
  s_cmp_ge_u32 s23, 144
  s_cbranch_scc1 p2_slowb
  v_cmp_lt_u32 vcc, 16, v11
  s_sleep 5
  s_cbranch_vccnz p2_pollb
  s_sleep 12
  s_branch p2_pollb
p2_slowb:
  s_sleep 48
  s_branch p2_pollb
p2_pdoneb:
  s_mov_b64 exec, -1
p2_polledb:
  v_mov_b32 v11, 0
  v_mov_b32 v116, 0
  v_mov_b32 v117, 0
  v_mov_b32 v118, 0
  v_mov_b32 v119, 0
  ds_write_b128 v11, v[116:119] offset:1152
  s_waitcnt lgkmcnt(0)
  s_barrier
  s_cmp_ge_u32 s22, 2
  s_cbranch_scc1 p2_nost
  v_lshlrev_b32 v10, 6, v0
  s_mov_b32 s41, 15204352
  buffer_load_dwordx4 v[72:75], v10, s[8:11], s41 offen offset:0 sc1
  buffer_load_dwordx4 v[76:79], v10, s[8:11], s41 offen offset:16 sc1
  buffer_load_dwordx4 v[80:83], v10, s[8:11], s41 offen offset:32 sc1
  buffer_load_dwordx4 v[84:87], v10, s[8:11], s41 offen offset:48 sc1
  s_add_u32 s41, s41, 8192
  buffer_load_dwordx4 v[88:91], v10, s[8:11], s41 offen offset:0 sc1
  buffer_load_dwordx4 v[92:95], v10, s[8:11], s41 offen offset:16 sc1
  buffer_load_dwordx4 v[96:99], v10, s[8:11], s41 offen offset:32 sc1
  buffer_load_dwordx4 v[100:103], v10, s[8:11], s41 offen offset:48 sc1
  s_add_u32 s41, s41, 8192
  buffer_load_dwordx4 v[104:107], v10, s[8:11], s41 offen offset:0 sc1
  buffer_load_dwordx4 v[108:111], v10, s[8:11], s41 offen offset:16 sc1
  buffer_load_dwordx4 v[112:115], v10, s[8:11], s41 offen offset:32 sc1
  buffer_load_dwordx4 v[116:119], v10, s[8:11], s41 offen offset:48 sc1
  s_branch p2_skipdma
p2_nost:
  s_cmp_ge_u32 s23, 144
  s_cbranch_scc1 p2_skipdma
p2_dma:
  s_add_u32 m0, s51, 4096
  s_add_u32 s53, s53, 1
  buffer_load_dwordx4 v6, s[12:15], s50 offen lds
  s_add_u32 m0, s51, 40960
  s_add_u32 s51, s51, 2048
  buffer_load_dwordx4 v6, s[16:19], s50 offen lds
  s_add_u32 s50, s50, 294912
  s_cmp_lt_u32 s53, 18
  s_cbranch_scc1 p2_dma
p2_skipdma:
  s_lshl_b32 s42, s23, 3
  s_lshl_b32 s43, s22, 1
  s_add_u32 s42, s42, s43
  s_mul_i32 s43, s42, 1152
  s_add_u32 s44, s43, 12582912
  s_lshl_b32 s45, s42, 2
  s_add_u32 s45, s45, 15204352
  buffer_load_dwordx4 v[40:43], v4, s[8:11], s44 offen sc1
  buffer_load_dwordx4 v[44:47], v5, s[8:11], s44 offen sc1
  buffer_load_dwordx4 v[48:51], v4, s[8:11], s44 offen offset:1152 sc1
  buffer_load_dwordx4 v[52:55], v5, s[8:11], s44 offen offset:1152 sc1
  buffer_load_dwordx2 v[56:57], v11, s[8:11], s45 offen sc1
  s_add_u32 s45, s45, 8192
  buffer_load_dwordx2 v[58:59], v11, s[8:11], s45 offen sc1
  s_cmp_ge_u32 s22, 2
  s_cbranch_scc1 p2_noam
  v_lshlrev_b32 v12, 4, v0
  v_sub_u32 v12, 2047, v12
  s_waitcnt vmcnt(6)
  v_mul_f32 v120, 0x3ae38e39, v72
  v_mul_f32 v121, 0x3ae38e39, v88
  v_fma_f32 v121, -v120, v120, v121
  v_max_f32 v121, 0, v121
  v_add_f32 v121, 0x3727c5ac, v121
  v_rsq_f32 v121, v121
  v_fma_f32 v120, -v120, s48, v104
  v_mul_f32 v120, v120, v121
  v_ashrrev_i32 v122, 31, v120
  v_or_b32 v122, 0x80000000, v122
  v_xor_b32 v120, v120, v122
  v_and_b32 v120, 0xfffff800, v120
  v_subrev_u32 v122, 0, v12
  v_or_b32 v16, v120, v122
  v_mul_f32 v123, 0x3ae38e39, v73
  v_mul_f32 v124, 0x3ae38e39, v89
  v_fma_f32 v124, -v123, v123, v124
  v_max_f32 v124, 0, v124
  v_add_f32 v124, 0x3727c5ac, v124
  v_rsq_f32 v124, v124
  v_fma_f32 v123, -v123, s48, v105
  v_mul_f32 v123, v123, v124
  v_ashrrev_i32 v125, 31, v123
  v_or_b32 v125, 0x80000000, v125
  v_xor_b32 v123, v123, v125
  v_and_b32 v123, 0xfffff800, v123
  v_subrev_u32 v125, 1, v12
  v_or_b32 v17, v123, v125
  v_mul_f32 v126, 0x3ae38e39, v74
  v_mul_f32 v127, 0x3ae38e39, v90
  v_fma_f32 v127, -v126, v126, v127
  v_max_f32 v127, 0, v127
  v_add_f32 v127, 0x3727c5ac, v127
  v_rsq_f32 v127, v127
  v_fma_f32 v126, -v126, s48, v106
  v_mul_f32 v126, v126, v127
  v_ashrrev_i32 v128, 31, v126
  v_or_b32 v128, 0x80000000, v128
  v_xor_b32 v126, v126, v128
  v_and_b32 v126, 0xfffff800, v126
  v_subrev_u32 v128, 2, v12
  v_or_b32 v18, v126, v128
  v_mul_f32 v129, 0x3ae38e39, v75
  v_mul_f32 v130, 0x3ae38e39, v91
  v_fma_f32 v130, -v129, v129, v130
  v_max_f32 v130, 0, v130
  v_add_f32 v130, 0x3727c5ac, v130
  v_rsq_f32 v130, v130
  v_fma_f32 v129, -v129, s48, v107
  v_mul_f32 v129, v129, v130
  v_ashrrev_i32 v131, 31, v129
  v_or_b32 v131, 0x80000000, v131
  v_xor_b32 v129, v129, v131
  v_and_b32 v129, 0xfffff800, v129
  v_subrev_u32 v131, 3, v12
  v_or_b32 v19, v129, v131
  v_mul_f32 v120, 0x3ae38e39, v76
  v_mul_f32 v121, 0x3ae38e39, v92
  v_fma_f32 v121, -v120, v120, v121
  v_max_f32 v121, 0, v121
  v_add_f32 v121, 0x3727c5ac, v121
  v_rsq_f32 v121, v121
  v_fma_f32 v120, -v120, s48, v108
  v_mul_f32 v120, v120, v121
  v_ashrrev_i32 v122, 31, v120
  v_or_b32 v122, 0x80000000, v122
  v_xor_b32 v120, v120, v122
  v_and_b32 v120, 0xfffff800, v120
  v_subrev_u32 v122, 4, v12
  v_or_b32 v20, v120, v122
  v_mul_f32 v123, 0x3ae38e39, v77
  v_mul_f32 v124, 0x3ae38e39, v93
  v_fma_f32 v124, -v123, v123, v124
  v_max_f32 v124, 0, v124
  v_add_f32 v124, 0x3727c5ac, v124
  v_rsq_f32 v124, v124
  v_fma_f32 v123, -v123, s48, v109
  v_mul_f32 v123, v123, v124
  v_ashrrev_i32 v125, 31, v123
  v_or_b32 v125, 0x80000000, v125
  v_xor_b32 v123, v123, v125
  v_and_b32 v123, 0xfffff800, v123
  v_subrev_u32 v125, 5, v12
  v_or_b32 v21, v123, v125
  v_mul_f32 v126, 0x3ae38e39, v78
  v_mul_f32 v127, 0x3ae38e39, v94
  v_fma_f32 v127, -v126, v126, v127
  v_max_f32 v127, 0, v127
  v_add_f32 v127, 0x3727c5ac, v127
  v_rsq_f32 v127, v127
  v_fma_f32 v126, -v126, s48, v110
  v_mul_f32 v126, v126, v127
  v_ashrrev_i32 v128, 31, v126
  v_or_b32 v128, 0x80000000, v128
  v_xor_b32 v126, v126, v128
  v_and_b32 v126, 0xfffff800, v126
  v_subrev_u32 v128, 6, v12
  v_or_b32 v22, v126, v128
  v_mul_f32 v129, 0x3ae38e39, v79
  v_mul_f32 v130, 0x3ae38e39, v95
  v_fma_f32 v130, -v129, v129, v130
  v_max_f32 v130, 0, v130
  v_add_f32 v130, 0x3727c5ac, v130
  v_rsq_f32 v130, v130
  v_fma_f32 v129, -v129, s48, v111
  v_mul_f32 v129, v129, v130
  v_ashrrev_i32 v131, 31, v129
  v_or_b32 v131, 0x80000000, v131
  v_xor_b32 v129, v129, v131
  v_and_b32 v129, 0xfffff800, v129
  v_subrev_u32 v131, 7, v12
  v_or_b32 v23, v129, v131
  v_mul_f32 v120, 0x3ae38e39, v80
  v_mul_f32 v121, 0x3ae38e39, v96
  v_fma_f32 v121, -v120, v120, v121
  v_max_f32 v121, 0, v121
  v_add_f32 v121, 0x3727c5ac, v121
  v_rsq_f32 v121, v121
  v_fma_f32 v120, -v120, s48, v112
  v_mul_f32 v120, v120, v121
  v_ashrrev_i32 v122, 31, v120
  v_or_b32 v122, 0x80000000, v122
  v_xor_b32 v120, v120, v122
  v_and_b32 v120, 0xfffff800, v120
  v_subrev_u32 v122, 8, v12
  v_or_b32 v24, v120, v122
  v_mul_f32 v123, 0x3ae38e39, v81
  v_mul_f32 v124, 0x3ae38e39, v97
  v_fma_f32 v124, -v123, v123, v124
  v_max_f32 v124, 0, v124
  v_add_f32 v124, 0x3727c5ac, v124
  v_rsq_f32 v124, v124
  v_fma_f32 v123, -v123, s48, v113
  v_mul_f32 v123, v123, v124
  v_ashrrev_i32 v125, 31, v123
  v_or_b32 v125, 0x80000000, v125
  v_xor_b32 v123, v123, v125
  v_and_b32 v123, 0xfffff800, v123
  v_subrev_u32 v125, 9, v12
  v_or_b32 v25, v123, v125
  v_mul_f32 v126, 0x3ae38e39, v82
  v_mul_f32 v127, 0x3ae38e39, v98
  v_fma_f32 v127, -v126, v126, v127
  v_max_f32 v127, 0, v127
  v_add_f32 v127, 0x3727c5ac, v127
  v_rsq_f32 v127, v127
  v_fma_f32 v126, -v126, s48, v114
  v_mul_f32 v126, v126, v127
  v_ashrrev_i32 v128, 31, v126
  v_or_b32 v128, 0x80000000, v128
  v_xor_b32 v126, v126, v128
  v_and_b32 v126, 0xfffff800, v126
  v_subrev_u32 v128, 10, v12
  v_or_b32 v26, v126, v128
  v_mul_f32 v129, 0x3ae38e39, v83
  v_mul_f32 v130, 0x3ae38e39, v99
  v_fma_f32 v130, -v129, v129, v130
  v_max_f32 v130, 0, v130
  v_add_f32 v130, 0x3727c5ac, v130
  v_rsq_f32 v130, v130
  v_fma_f32 v129, -v129, s48, v115
  v_mul_f32 v129, v129, v130
  v_ashrrev_i32 v131, 31, v129
  v_or_b32 v131, 0x80000000, v131
  v_xor_b32 v129, v129, v131
  v_and_b32 v129, 0xfffff800, v129
  v_subrev_u32 v131, 11, v12
  v_or_b32 v27, v129, v131
  v_mul_f32 v120, 0x3ae38e39, v84
  v_mul_f32 v121, 0x3ae38e39, v100
  v_fma_f32 v121, -v120, v120, v121
  v_max_f32 v121, 0, v121
  v_add_f32 v121, 0x3727c5ac, v121
  v_rsq_f32 v121, v121
  v_fma_f32 v120, -v120, s48, v116
  v_mul_f32 v120, v120, v121
  v_ashrrev_i32 v122, 31, v120
  v_or_b32 v122, 0x80000000, v122
  v_xor_b32 v120, v120, v122
  v_and_b32 v120, 0xfffff800, v120
  v_subrev_u32 v122, 12, v12
  v_or_b32 v28, v120, v122
  v_mul_f32 v123, 0x3ae38e39, v85
  v_mul_f32 v124, 0x3ae38e39, v101
  v_fma_f32 v124, -v123, v123, v124
  v_max_f32 v124, 0, v124
  v_add_f32 v124, 0x3727c5ac, v124
  v_rsq_f32 v124, v124
  v_fma_f32 v123, -v123, s48, v117
  v_mul_f32 v123, v123, v124
  v_ashrrev_i32 v125, 31, v123
  v_or_b32 v125, 0x80000000, v125
  v_xor_b32 v123, v123, v125
  v_and_b32 v123, 0xfffff800, v123
  v_subrev_u32 v125, 13, v12
  v_or_b32 v29, v123, v125
  v_mul_f32 v126, 0x3ae38e39, v86
  v_mul_f32 v127, 0x3ae38e39, v102
  v_fma_f32 v127, -v126, v126, v127
  v_max_f32 v127, 0, v127
  v_add_f32 v127, 0x3727c5ac, v127
  v_rsq_f32 v127, v127
  v_fma_f32 v126, -v126, s48, v118
  v_mul_f32 v126, v126, v127
  v_ashrrev_i32 v128, 31, v126
  v_or_b32 v128, 0x80000000, v128
  v_xor_b32 v126, v126, v128
  v_and_b32 v126, 0xfffff800, v126
  v_subrev_u32 v128, 14, v12
  v_or_b32 v30, v126, v128
  v_mul_f32 v129, 0x3ae38e39, v87
  v_mul_f32 v130, 0x3ae38e39, v103
  v_fma_f32 v130, -v129, v129, v130
  v_max_f32 v130, 0, v130
  v_add_f32 v130, 0x3727c5ac, v130
  v_rsq_f32 v130, v130
  v_fma_f32 v129, -v129, s48, v119
  v_mul_f32 v129, v129, v130
  v_ashrrev_i32 v131, 31, v129
  v_or_b32 v131, 0x80000000, v131
  v_xor_b32 v129, v129, v131
  v_and_b32 v129, 0xfffff800, v129
  v_subrev_u32 v131, 15, v12
  v_or_b32 v31, v129, v131
  v_max3_u32 v16, v16, v17, v18
  v_max3_u32 v19, v19, v20, v21
  v_max3_u32 v22, v22, v23, v24
  v_max3_u32 v25, v25, v26, v27
  v_max3_u32 v28, v28, v29, v30
  v_max3_u32 v16, v16, v19, v22
  v_max3_u32 v25, v25, v28, v31
  v_max_u32 v16, v16, v25
  s_lshl_b32 s49, s22, 3
  v_mov_b32 v13, s49
  v_max_u32_dpp v16, v16, v16 row_shr:1 row_mask:0xf bank_mask:0xf
  v_xor_b32 v14, 8, v13
  v_mov_b32 v17, 1
  v_max_u32_dpp v16, v16, v16 row_shr:2 row_mask:0xf bank_mask:0xf
  s_nop 1
  v_max_u32_dpp v16, v16, v16 row_shr:4 row_mask:0xf bank_mask:0xf
  s_nop 1
  v_max_u32_dpp v16, v16, v16 row_shr:8 row_mask:0xf bank_mask:0xf
  s_nop 1
  v_max_u32_dpp v16, v16, v16 row_bcast:15 row_mask:0xa bank_mask:0xf
  s_nop 1
  v_max_u32_dpp v16, v16, v16 row_bcast:31 row_mask:0xc bank_mask:0xf
  s_mov_b32 exec_lo, 0
  s_mov_b32 exec_hi, 0x80000000
  ds_write_b64 v13, v[16:17] offset:1152
  s_mov_b64 exec, -1
  v_readlane_b32 s53, v16, 63
p2_spin:
  ds_read_b64 v[116:117], v14 offset:1152
  s_waitcnt lgkmcnt(0)
  v_readfirstlane_b32 s54, v117
  v_readfirstlane_b32 s55, v116
  s_nop 1
  s_cmp_eq_u32 s54, 0
  s_cbranch_scc1 p2_spin
  s_max_u32 s53, s53, s55
  s_and_b32 s53, s53, 0x7ff
  s_sub_u32 s53, 2047, s53
  s_sub_u32 s55, s23, 144
  s_cmp_lt_u32 s55, 111
  s_cbranch_scc1 p2_noam
  s_mul_i32 s54, s53, 1152
  s_add_u32 s55, s54, 12582912
  s_lshl_b32 s56, s53, 2
  s_add_u32 s56, s56, 15204352
  buffer_load_dwordx4 v[60:63], v15, s[8:11], s55 offen sc1
  buffer_load_dword v64, v11, s[8:11], s56 offen sc1
  s_add_u32 s56, s56, 8192
  buffer_load_dword v65, v11, s[8:11], s56 offen sc1
  s_add_u32 s56, s56, 8192
  buffer_load_dword v66, v11, s[8:11], s56 offen sc1
  s_waitcnt vmcnt(0)
  v_mul_f32 v69, 0x3ae38e39, v64
  v_mul_f32 v70, 0x3ae38e39, v65
  v_fma_f32 v70, -v69, v69, v70
  v_max_f32 v70, 0, v70
  v_cvt_pk_bf16_f32 v69, v69, v69
  v_cvt_pk_bf16_f32 v70, v70, v70
  v_and_b32 v69, 0xffff0000, v69
  v_and_b32 v70, 0xffff0000, v70
  v_add_f32 v70, 0x3727c5ac, v70
  v_cvt_pk_bf16_f32 v70, v70, v70
  v_and_b32 v70, 0xffff0000, v70
  v_sqrt_f32 v70, v70
  s_nop 0
  v_cvt_pk_bf16_f32 v70, v70, v70
  v_and_b32 v70, 0xffff0000, v70
  v_rcp_f32 v70, v70
  s_nop 0
  v_lshlrev_b32 v116, 16, v60
  v_and_b32 v117, 0xffff0000, v60
  v_lshlrev_b32 v118, 16, v61
  v_and_b32 v119, 0xffff0000, v61
  v_lshlrev_b32 v120, 16, v62
  v_and_b32 v121, 0xffff0000, v62
  v_lshlrev_b32 v122, 16, v63
  v_and_b32 v123, 0xffff0000, v63
  v_sub_f32 v132, v116, v69
  v_sub_f32 v133, v117, v69
  v_sub_f32 v134, v118, v69
  v_sub_f32 v135, v119, v69
  v_sub_f32 v136, v120, v69
  v_sub_f32 v137, v121, v69
  v_sub_f32 v138, v122, v69
  v_sub_f32 v139, v123, v69
  v_cvt_pk_bf16_f32 v124, v132, v133
  v_cvt_pk_bf16_f32 v125, v134, v135
  v_cvt_pk_bf16_f32 v126, v136, v137
  v_cvt_pk_bf16_f32 v127, v138, v139
  v_lshlrev_b32 v132, 16, v124
  v_and_b32 v133, 0xffff0000, v124
  v_lshlrev_b32 v134, 16, v125
  v_and_b32 v135, 0xffff0000, v125
  v_lshlrev_b32 v136, 16, v126
  v_and_b32 v137, 0xffff0000, v126
  v_lshlrev_b32 v138, 16, v127
  v_and_b32 v139, 0xffff0000, v127
  v_mul_f32 v132, v132, v70
  v_mul_f32 v133, v133, v70
  v_mul_f32 v134, v134, v70
  v_mul_f32 v135, v135, v70
  v_mul_f32 v136, v136, v70
  v_mul_f32 v137, v137, v70
  v_mul_f32 v138, v138, v70
  v_mul_f32 v139, v139, v70
  v_cvt_pk_bf16_f32 v124, v132, v133
  v_cvt_pk_bf16_f32 v125, v134, v135
  v_cvt_pk_bf16_f32 v126, v136, v137
  v_cvt_pk_bf16_f32 v127, v138, v139
  v_cmp_gt_u32 vcc, 72, v0
  s_and_saveexec_b64 s[62:63], vcc
  ds_write_b128 v3, v[124:127] offset:0
  s_mov_b64 exec, s[62:63]
p2_noam:
  s_waitcnt vmcnt(0) lgkmcnt(0)
  s_barrier
  s_cmp_lt_u32 s22, 2
  s_cbranch_scc1 p2_haveidx
  ds_read_b128 v[132:135], v11 offset:1152
  s_waitcnt lgkmcnt(0)
  v_max_u32 v132, v132, v134
  s_nop 0
  v_readfirstlane_b32 s53, v132
  s_nop 1
  s_and_b32 s53, s53, 0x7ff
  s_sub_u32 s53, 2047, s53
p2_haveidx:
  s_cmp_lt_u32 s23, 144
  s_cbranch_scc1 p2_ffn
  v_mul_f32 v67, 0x3ae38e39, v56
  v_mul_f32 v68, 0x3ae38e39, v58
  v_fma_f32 v68, -v67, v67, v68
  v_max_f32 v68, 0, v68
  v_cvt_pk_bf16_f32 v67, v67, v67
  v_cvt_pk_bf16_f32 v68, v68, v68
  v_and_b32 v67, 0xffff0000, v67
  v_and_b32 v68, 0xffff0000, v68
  v_add_f32 v68, 0x3727c5ac, v68
  v_cvt_pk_bf16_f32 v68, v68, v68
  v_and_b32 v68, 0xffff0000, v68
  v_sqrt_f32 v68, v68
  s_nop 0
  v_cvt_pk_bf16_f32 v68, v68, v68
  v_and_b32 v68, 0xffff0000, v68
  v_rcp_f32 v68, v68
  s_nop 0
  v_lshlrev_b32 v16, 16, v40
  v_and_b32 v17, 0xffff0000, v40
  v_lshlrev_b32 v18, 16, v41
  v_and_b32 v19, 0xffff0000, v41
  v_lshlrev_b32 v20, 16, v42
  v_and_b32 v21, 0xffff0000, v42
  v_lshlrev_b32 v22, 16, v43
  v_and_b32 v23, 0xffff0000, v43
  v_lshlrev_b32 v24, 16, v44
  v_and_b32 v25, 0xffff0000, v44
  v_lshlrev_b32 v26, 16, v45
  v_and_b32 v27, 0xffff0000, v45
  v_lshlrev_b32 v28, 16, v46
  v_and_b32 v29, 0xffff0000, v46
  v_lshlrev_b32 v30, 16, v47
  v_and_b32 v31, 0xffff0000, v47
  v_sub_f32 v132, v16, v67
  v_sub_f32 v133, v17, v67
  v_sub_f32 v134, v18, v67
  v_sub_f32 v135, v19, v67
  v_sub_f32 v136, v20, v67
  v_sub_f32 v137, v21, v67
  v_sub_f32 v138, v22, v67
  v_sub_f32 v139, v23, v67
  v_sub_f32 v140, v24, v67
  v_sub_f32 v141, v25, v67
  v_sub_f32 v142, v26, v67
  v_sub_f32 v143, v27, v67
  v_sub_f32 v144, v28, v67
  v_sub_f32 v145, v29, v67
  v_sub_f32 v146, v30, v67
  v_sub_f32 v147, v31, v67
  v_cvt_pk_bf16_f32 v32, v132, v133
  v_cvt_pk_bf16_f32 v33, v134, v135
  v_cvt_pk_bf16_f32 v34, v136, v137
  v_cvt_pk_bf16_f32 v35, v138, v139
  v_cvt_pk_bf16_f32 v36, v140, v141
  v_cvt_pk_bf16_f32 v37, v142, v143
  v_cvt_pk_bf16_f32 v38, v144, v145
  v_cvt_pk_bf16_f32 v39, v146, v147
  v_lshlrev_b32 v132, 16, v32
  v_and_b32 v133, 0xffff0000, v32
  v_lshlrev_b32 v134, 16, v33
  v_and_b32 v135, 0xffff0000, v33
  v_lshlrev_b32 v136, 16, v34
  v_and_b32 v137, 0xffff0000, v34
  v_lshlrev_b32 v138, 16, v35
  v_and_b32 v139, 0xffff0000, v35
  v_lshlrev_b32 v140, 16, v36
  v_and_b32 v141, 0xffff0000, v36
  v_lshlrev_b32 v142, 16, v37
  v_and_b32 v143, 0xffff0000, v37
  v_lshlrev_b32 v144, 16, v38
  v_and_b32 v145, 0xffff0000, v38
  v_lshlrev_b32 v146, 16, v39
  v_and_b32 v147, 0xffff0000, v39
  v_mul_f32 v132, v132, v68
  v_mul_f32 v133, v133, v68
  v_mul_f32 v134, v134, v68
  v_mul_f32 v135, v135, v68
  v_mul_f32 v136, v136, v68
  v_mul_f32 v137, v137, v68
  v_mul_f32 v138, v138, v68
  v_mul_f32 v139, v139, v68
  v_mul_f32 v140, v140, v68
  v_mul_f32 v141, v141, v68
  v_mul_f32 v142, v142, v68
  v_mul_f32 v143, v143, v68
  v_mul_f32 v144, v144, v68
  v_mul_f32 v145, v145, v68
  v_mul_f32 v146, v146, v68
  v_mul_f32 v147, v147, v68
  v_cvt_pk_bf16_f32 v32, v132, v133
  v_cvt_pk_bf16_f32 v33, v134, v135
  v_cvt_pk_bf16_f32 v34, v136, v137
  v_cvt_pk_bf16_f32 v35, v138, v139
  v_cvt_pk_bf16_f32 v36, v140, v141
  v_cvt_pk_bf16_f32 v37, v142, v143
  v_cvt_pk_bf16_f32 v38, v144, v145
  v_cvt_pk_bf16_f32 v39, v146, v147
  v_lshlrev_b32 v132, 16, v32
  v_and_b32 v133, 0xffff0000, v32
  v_lshlrev_b32 v134, 16, v33
  v_and_b32 v135, 0xffff0000, v33
  v_lshlrev_b32 v136, 16, v34
  v_and_b32 v137, 0xffff0000, v34
  v_lshlrev_b32 v138, 16, v35
  v_and_b32 v139, 0xffff0000, v35
  v_lshlrev_b32 v140, 16, v36
  v_and_b32 v141, 0xffff0000, v36
  v_lshlrev_b32 v142, 16, v37
  v_and_b32 v143, 0xffff0000, v37
  v_lshlrev_b32 v144, 16, v38
  v_and_b32 v145, 0xffff0000, v38
  v_lshlrev_b32 v146, 16, v39
  v_and_b32 v147, 0xffff0000, v39
  v_add_f32 v132, v132, v16
  v_add_f32 v133, v133, v17
  v_add_f32 v134, v134, v18
  v_add_f32 v135, v135, v19
  v_add_f32 v136, v136, v20
  v_add_f32 v137, v137, v21
  v_add_f32 v138, v138, v22
  v_add_f32 v139, v139, v23
  v_add_f32 v140, v140, v24
  v_add_f32 v141, v141, v25
  v_add_f32 v142, v142, v26
  v_add_f32 v143, v143, v27
  v_add_f32 v144, v144, v28
  v_add_f32 v145, v145, v29
  v_add_f32 v146, v146, v30
  v_add_f32 v147, v147, v31
  v_cvt_pk_bf16_f32 v40, v132, v133
  v_cvt_pk_bf16_f32 v41, v134, v135
  v_cvt_pk_bf16_f32 v42, v136, v137
  v_cvt_pk_bf16_f32 v43, v138, v139
  v_cvt_pk_bf16_f32 v44, v140, v141
  v_cvt_pk_bf16_f32 v45, v142, v143
  v_cvt_pk_bf16_f32 v46, v144, v145
  v_cvt_pk_bf16_f32 v47, v146, v147
  s_add_u32 s57, s42, 0
  s_add_u32 s58, s43, 0
  s_cmp_eq_u32 s57, s53
  s_cselect_b32 s58, 1073741824, s58
  buffer_store_dwordx4 v[40:43], v4, s[28:31], s58 offen
  buffer_store_dwordx4 v[44:47], v5, s[28:31], s58 offen
  v_mul_f32 v67, 0x3ae38e39, v57
  v_mul_f32 v68, 0x3ae38e39, v59
  v_fma_f32 v68, -v67, v67, v68
  v_max_f32 v68, 0, v68
  v_cvt_pk_bf16_f32 v67, v67, v67
  v_cvt_pk_bf16_f32 v68, v68, v68
  v_and_b32 v67, 0xffff0000, v67
  v_and_b32 v68, 0xffff0000, v68
  v_add_f32 v68, 0x3727c5ac, v68
  v_cvt_pk_bf16_f32 v68, v68, v68
  v_and_b32 v68, 0xffff0000, v68
  v_sqrt_f32 v68, v68
  s_nop 0
  v_cvt_pk_bf16_f32 v68, v68, v68
  v_and_b32 v68, 0xffff0000, v68
  v_rcp_f32 v68, v68
  s_nop 0
  v_lshlrev_b32 v16, 16, v48
  v_and_b32 v17, 0xffff0000, v48
  v_lshlrev_b32 v18, 16, v49
  v_and_b32 v19, 0xffff0000, v49
  v_lshlrev_b32 v20, 16, v50
  v_and_b32 v21, 0xffff0000, v50
  v_lshlrev_b32 v22, 16, v51
  v_and_b32 v23, 0xffff0000, v51
  v_lshlrev_b32 v24, 16, v52
  v_and_b32 v25, 0xffff0000, v52
  v_lshlrev_b32 v26, 16, v53
  v_and_b32 v27, 0xffff0000, v53
  v_lshlrev_b32 v28, 16, v54
  v_and_b32 v29, 0xffff0000, v54
  v_lshlrev_b32 v30, 16, v55
  v_and_b32 v31, 0xffff0000, v55
  v_sub_f32 v132, v16, v67
  v_sub_f32 v133, v17, v67
  v_sub_f32 v134, v18, v67
  v_sub_f32 v135, v19, v67
  v_sub_f32 v136, v20, v67
  v_sub_f32 v137, v21, v67
  v_sub_f32 v138, v22, v67
  v_sub_f32 v139, v23, v67
  v_sub_f32 v140, v24, v67
  v_sub_f32 v141, v25, v67
  v_sub_f32 v142, v26, v67
  v_sub_f32 v143, v27, v67
  v_sub_f32 v144, v28, v67
  v_sub_f32 v145, v29, v67
  v_sub_f32 v146, v30, v67
  v_sub_f32 v147, v31, v67
  v_cvt_pk_bf16_f32 v32, v132, v133
  v_cvt_pk_bf16_f32 v33, v134, v135
  v_cvt_pk_bf16_f32 v34, v136, v137
  v_cvt_pk_bf16_f32 v35, v138, v139
  v_cvt_pk_bf16_f32 v36, v140, v141
  v_cvt_pk_bf16_f32 v37, v142, v143
  v_cvt_pk_bf16_f32 v38, v144, v145
  v_cvt_pk_bf16_f32 v39, v146, v147
  v_lshlrev_b32 v132, 16, v32
  v_and_b32 v133, 0xffff0000, v32
  v_lshlrev_b32 v134, 16, v33
  v_and_b32 v135, 0xffff0000, v33
  v_lshlrev_b32 v136, 16, v34
  v_and_b32 v137, 0xffff0000, v34
  v_lshlrev_b32 v138, 16, v35
  v_and_b32 v139, 0xffff0000, v35
  v_lshlrev_b32 v140, 16, v36
  v_and_b32 v141, 0xffff0000, v36
  v_lshlrev_b32 v142, 16, v37
  v_and_b32 v143, 0xffff0000, v37
  v_lshlrev_b32 v144, 16, v38
  v_and_b32 v145, 0xffff0000, v38
  v_lshlrev_b32 v146, 16, v39
  v_and_b32 v147, 0xffff0000, v39
  v_mul_f32 v132, v132, v68
  v_mul_f32 v133, v133, v68
  v_mul_f32 v134, v134, v68
  v_mul_f32 v135, v135, v68
  v_mul_f32 v136, v136, v68
  v_mul_f32 v137, v137, v68
  v_mul_f32 v138, v138, v68
  v_mul_f32 v139, v139, v68
  v_mul_f32 v140, v140, v68
  v_mul_f32 v141, v141, v68
  v_mul_f32 v142, v142, v68
  v_mul_f32 v143, v143, v68
  v_mul_f32 v144, v144, v68
  v_mul_f32 v145, v145, v68
  v_mul_f32 v146, v146, v68
  v_mul_f32 v147, v147, v68
  v_cvt_pk_bf16_f32 v32, v132, v133
  v_cvt_pk_bf16_f32 v33, v134, v135
  v_cvt_pk_bf16_f32 v34, v136, v137
  v_cvt_pk_bf16_f32 v35, v138, v139
  v_cvt_pk_bf16_f32 v36, v140, v141
  v_cvt_pk_bf16_f32 v37, v142, v143
  v_cvt_pk_bf16_f32 v38, v144, v145
  v_cvt_pk_bf16_f32 v39, v146, v147
  v_lshlrev_b32 v132, 16, v32
  v_and_b32 v133, 0xffff0000, v32
  v_lshlrev_b32 v134, 16, v33
  v_and_b32 v135, 0xffff0000, v33
  v_lshlrev_b32 v136, 16, v34
  v_and_b32 v137, 0xffff0000, v34
  v_lshlrev_b32 v138, 16, v35
  v_and_b32 v139, 0xffff0000, v35
  v_lshlrev_b32 v140, 16, v36
  v_and_b32 v141, 0xffff0000, v36
  v_lshlrev_b32 v142, 16, v37
  v_and_b32 v143, 0xffff0000, v37
  v_lshlrev_b32 v144, 16, v38
  v_and_b32 v145, 0xffff0000, v38
  v_lshlrev_b32 v146, 16, v39
  v_and_b32 v147, 0xffff0000, v39
  v_add_f32 v132, v132, v16
  v_add_f32 v133, v133, v17
  v_add_f32 v134, v134, v18
  v_add_f32 v135, v135, v19
  v_add_f32 v136, v136, v20
  v_add_f32 v137, v137, v21
  v_add_f32 v138, v138, v22
  v_add_f32 v139, v139, v23
  v_add_f32 v140, v140, v24
  v_add_f32 v141, v141, v25
  v_add_f32 v142, v142, v26
  v_add_f32 v143, v143, v27
  v_add_f32 v144, v144, v28
  v_add_f32 v145, v145, v29
  v_add_f32 v146, v146, v30
  v_add_f32 v147, v147, v31
  v_cvt_pk_bf16_f32 v48, v132, v133
  v_cvt_pk_bf16_f32 v49, v134, v135
  v_cvt_pk_bf16_f32 v50, v136, v137
  v_cvt_pk_bf16_f32 v51, v138, v139
  v_cvt_pk_bf16_f32 v52, v140, v141
  v_cvt_pk_bf16_f32 v53, v142, v143
  v_cvt_pk_bf16_f32 v54, v144, v145
  v_cvt_pk_bf16_f32 v55, v146, v147
  s_add_u32 s57, s42, 1
  s_add_u32 s58, s43, 1152
  s_cmp_eq_u32 s57, s53
  s_cselect_b32 s58, 1073741824, s58
  buffer_store_dwordx4 v[48:51], v4, s[28:31], s58 offen
  buffer_store_dwordx4 v[52:55], v5, s[28:31], s58 offen
  s_cmp_eq_u32 s23, 255
  s_cbranch_scc0 k34_end
  s_cmp_lt_u32 s22, 2
  s_cbranch_scc1 p2_final
  s_endpgm
p2_ffn:
  v_lshrrev_b32 v10, 4, v1
  v_bfe_u32 v13, v1, 2, 2
  v_lshl_add_u32 v13, v10, 3, v13
  v_and_b32 v14, 3, v1
  v_lshlrev_b32 v14, 3, v14
  v_lshl_add_u32 v13, v13, 6, v14
  s_and_b32 s61, s22, 1
  s_lshl_b32 s61, s61, 5
  s_lshr_b32 s64, s22, 1
  s_mul_i32 s64, s64, 36864
  s_add_u32 s61, s61, s64
  s_add_u32 s61, s61, 4096
  v_add_u32 v13, s61, v13
  v_lshlrev_b32 v14, 4, v10
  ds_read_b128 v[16:19], v14 offset:0
  ds_read_b64_tr_b16 v[72:73], v13 offset:0
  ds_read_b64_tr_b16 v[74:75], v13 offset:256
  ds_read_b128 v[20:23], v14 offset:64
  ds_read_b64_tr_b16 v[76:77], v13 offset:2048
  ds_read_b64_tr_b16 v[78:79], v13 offset:2304
  ds_read_b128 v[24:27], v14 offset:128
  ds_read_b64_tr_b16 v[80:81], v13 offset:4096
  ds_read_b64_tr_b16 v[82:83], v13 offset:4352
  ds_read_b128 v[28:31], v14 offset:192
  ds_read_b64_tr_b16 v[84:85], v13 offset:6144
  ds_read_b64_tr_b16 v[86:87], v13 offset:6400
  ds_read_b128 v[32:35], v14 offset:256
  ds_read_b64_tr_b16 v[88:89], v13 offset:8192
  ds_read_b64_tr_b16 v[90:91], v13 offset:8448
  s_waitcnt lgkmcnt(12)
  v_mfma_f32_16x16x32_bf16 v[128:131], v[16:19], v[72:75], 0
  ds_read_b128 v[36:39], v14 offset:320
  ds_read_b64_tr_b16 v[92:93], v13 offset:10240
  ds_read_b64_tr_b16 v[94:95], v13 offset:10496
  s_waitcnt lgkmcnt(12)
  v_mfma_f32_16x16x32_bf16 v[128:131], v[20:23], v[76:79], v[128:131]
  ds_read_b128 v[16:19], v14 offset:384
  ds_read_b64_tr_b16 v[72:73], v13 offset:12288
  ds_read_b64_tr_b16 v[74:75], v13 offset:12544
  s_waitcnt lgkmcnt(12)
  v_mfma_f32_16x16x32_bf16 v[128:131], v[24:27], v[80:83], v[128:131]
  ds_read_b128 v[20:23], v14 offset:448
  ds_read_b64_tr_b16 v[76:77], v13 offset:14336
  ds_read_b64_tr_b16 v[78:79], v13 offset:14592
  s_waitcnt lgkmcnt(12)
  v_mfma_f32_16x16x32_bf16 v[128:131], v[28:31], v[84:87], v[128:131]
  ds_read_b128 v[24:27], v14 offset:512
  ds_read_b64_tr_b16 v[80:81], v13 offset:16384
  ds_read_b64_tr_b16 v[82:83], v13 offset:16640
  s_waitcnt lgkmcnt(12)
  v_mfma_f32_16x16x32_bf16 v[128:131], v[32:35], v[88:91], v[128:131]
  ds_read_b128 v[28:31], v14 offset:576
  ds_read_b64_tr_b16 v[84:85], v13 offset:18432
  ds_read_b64_tr_b16 v[86:87], v13 offset:18688
  s_waitcnt lgkmcnt(12)
  v_mfma_f32_16x16x32_bf16 v[128:131], v[36:39], v[92:95], v[128:131]
  ds_read_b128 v[32:35], v14 offset:640
  ds_read_b64_tr_b16 v[88:89], v13 offset:20480
  ds_read_b64_tr_b16 v[90:91], v13 offset:20736
  s_waitcnt lgkmcnt(12)
  v_mfma_f32_16x16x32_bf16 v[128:131], v[16:19], v[72:75], v[128:131]
  ds_read_b128 v[36:39], v14 offset:704
  ds_read_b64_tr_b16 v[92:93], v13 offset:22528
  ds_read_b64_tr_b16 v[94:95], v13 offset:22784
  s_waitcnt lgkmcnt(12)
  v_mfma_f32_16x16x32_bf16 v[128:131], v[20:23], v[76:79], v[128:131]
  ds_read_b128 v[16:19], v14 offset:768
  ds_read_b64_tr_b16 v[72:73], v13 offset:24576
  ds_read_b64_tr_b16 v[74:75], v13 offset:24832
  s_waitcnt lgkmcnt(12)
  v_mfma_f32_16x16x32_bf16 v[128:131], v[24:27], v[80:83], v[128:131]
  ds_read_b128 v[20:23], v14 offset:832
  ds_read_b64_tr_b16 v[76:77], v13 offset:26624
  ds_read_b64_tr_b16 v[78:79], v13 offset:26880
  s_waitcnt lgkmcnt(12)
  v_mfma_f32_16x16x32_bf16 v[128:131], v[28:31], v[84:87], v[128:131]
  ds_read_b128 v[24:27], v14 offset:896
  ds_read_b64_tr_b16 v[80:81], v13 offset:28672
  ds_read_b64_tr_b16 v[82:83], v13 offset:28928
  s_waitcnt lgkmcnt(12)
  v_mfma_f32_16x16x32_bf16 v[128:131], v[32:35], v[88:91], v[128:131]
  ds_read_b128 v[28:31], v14 offset:960
  ds_read_b64_tr_b16 v[84:85], v13 offset:30720
  ds_read_b64_tr_b16 v[86:87], v13 offset:30976
  s_waitcnt lgkmcnt(12)
  v_mfma_f32_16x16x32_bf16 v[128:131], v[36:39], v[92:95], v[128:131]
  ds_read_b128 v[32:35], v14 offset:1024
  ds_read_b64_tr_b16 v[88:89], v13 offset:32768
  ds_read_b64_tr_b16 v[90:91], v13 offset:33024
  s_waitcnt lgkmcnt(12)
  v_mfma_f32_16x16x32_bf16 v[128:131], v[16:19], v[72:75], v[128:131]
  ds_read_b128 v[36:39], v14 offset:1088
  ds_read_b64_tr_b16 v[92:93], v13 offset:34816
  ds_read_b64_tr_b16 v[94:95], v13 offset:35072
  s_waitcnt lgkmcnt(12)
  v_mfma_f32_16x16x32_bf16 v[128:131], v[20:23], v[76:79], v[128:131]
  s_waitcnt lgkmcnt(9)
  v_mfma_f32_16x16x32_bf16 v[128:131], v[24:27], v[80:83], v[128:131]
  s_waitcnt lgkmcnt(6)
  v_mfma_f32_16x16x32_bf16 v[128:131], v[28:31], v[84:87], v[128:131]
  s_waitcnt lgkmcnt(3)
  v_mfma_f32_16x16x32_bf16 v[128:131], v[32:35], v[88:91], v[128:131]
  s_waitcnt lgkmcnt(0)
  v_mfma_f32_16x16x32_bf16 v[128:131], v[36:39], v[92:95], v[128:131]
  s_lshl_b32 s65, s22, 6
  v_and_b32 v13, 15, v1
  v_lshl_add_u32 v13, v13, 2, s65
  v_and_b32 v14, 31, v1
  v_lshlrev_b32 v14, 2, v14
  v_lshlrev_b32 v9, 2, v7
  s_nop 3
  ds_write_b32 v13, v128 offset:1280
  s_waitcnt lgkmcnt(0)
  s_barrier
  ds_read_b32 v132, v14 offset:1280
  ds_read_b32 v134, v14 offset:1408
  s_waitcnt lgkmcnt(0)
  v_cvt_pk_bf16_f32 v132, v132, v134
  v_lshlrev_b32 v133, 16, v132
  v_and_b32 v134, 0xffff0000, v132
  v_mul_f32 v135, 0xbfb8aa3b, v133
  v_exp_f32 v135, v135
  s_nop 0
  v_add_f32 v135, 1.0, v135
  v_rcp_f32 v135, v135
  s_nop 0
  v_mul_f32 v133, v133, v135
  v_cvt_pk_bf16_f32 v133, v133, v133
  v_and_b32 v133, 0xffff0000, v133
  v_mul_f32 v133, v133, v134
  v_cvt_pk_bf16_f32 v133, v133, v133
  v_and_b32 v133, 0xffff0000, v133
  v_cmp_gt_u32 s[62:63], 32, v1
  v_lshlrev_b32 v13, 2, v1
  s_lshl_b32 s65, s22, 8
  v_cndmask_b32 v133, 0, v133, s[62:63]
  v_add_u32 v13, s65, v13
  v_add_u32 v9, s65, v9
  ds_write_b32 v13, v133 offset:1856
  s_waitcnt lgkmcnt(0)
  ds_read_b32 v16, v9 offset:1856
  ds_read_b32 v18, v9 offset:1868
  ds_read_b32 v20, v9 offset:1880
  ds_read_b32 v22, v9 offset:1892
  ds_read_b32 v24, v9 offset:1904
  ds_read_b32 v26, v9 offset:1916
  ds_read_b32 v28, v9 offset:1928
  ds_read_b32 v30, v9 offset:1940
  ds_read_b32 v32, v9 offset:1952
  ds_read_b32 v34, v9 offset:1964
  ds_read_b32 v36, v9 offset:1976
  s_waitcnt lgkmcnt(10)
  v_pk_mul_f32 v[136:137], v[152:153], v[16:17] op_sel_hi:[1,0]
  v_pk_mul_f32 v[138:139], v[154:155], v[16:17] op_sel_hi:[1,0]
  v_pk_mul_f32 v[140:141], v[156:157], v[16:17] op_sel_hi:[1,0]
  v_pk_mul_f32 v[142:143], v[158:159], v[16:17] op_sel_hi:[1,0]
  s_waitcnt lgkmcnt(9)
  v_pk_fma_f32 v[136:137], v[160:161], v[18:19], v[136:137] op_sel_hi:[1,0,1]
  v_pk_fma_f32 v[138:139], v[162:163], v[18:19], v[138:139] op_sel_hi:[1,0,1]
  v_pk_fma_f32 v[140:141], v[164:165], v[18:19], v[140:141] op_sel_hi:[1,0,1]
  v_pk_fma_f32 v[142:143], v[166:167], v[18:19], v[142:143] op_sel_hi:[1,0,1]
  s_waitcnt lgkmcnt(8)
  v_pk_fma_f32 v[136:137], v[168:169], v[20:21], v[136:137] op_sel_hi:[1,0,1]
  v_pk_fma_f32 v[138:139], v[170:171], v[20:21], v[138:139] op_sel_hi:[1,0,1]
  v_pk_fma_f32 v[140:141], v[172:173], v[20:21], v[140:141] op_sel_hi:[1,0,1]
  v_pk_fma_f32 v[142:143], v[174:175], v[20:21], v[142:143] op_sel_hi:[1,0,1]
  s_waitcnt lgkmcnt(7)
  v_pk_fma_f32 v[136:137], v[176:177], v[22:23], v[136:137] op_sel_hi:[1,0,1]
  v_pk_fma_f32 v[138:139], v[178:179], v[22:23], v[138:139] op_sel_hi:[1,0,1]
  v_pk_fma_f32 v[140:141], v[180:181], v[22:23], v[140:141] op_sel_hi:[1,0,1]
  v_pk_fma_f32 v[142:143], v[182:183], v[22:23], v[142:143] op_sel_hi:[1,0,1]
  s_waitcnt lgkmcnt(6)
  v_pk_fma_f32 v[136:137], v[184:185], v[24:25], v[136:137] op_sel_hi:[1,0,1]
  v_pk_fma_f32 v[138:139], v[186:187], v[24:25], v[138:139] op_sel_hi:[1,0,1]
  v_pk_fma_f32 v[140:141], v[188:189], v[24:25], v[140:141] op_sel_hi:[1,0,1]
  v_pk_fma_f32 v[142:143], v[190:191], v[24:25], v[142:143] op_sel_hi:[1,0,1]
  s_waitcnt lgkmcnt(5)
  v_pk_fma_f32 v[136:137], v[192:193], v[26:27], v[136:137] op_sel_hi:[1,0,1]
  v_pk_fma_f32 v[138:139], v[194:195], v[26:27], v[138:139] op_sel_hi:[1,0,1]
  v_pk_fma_f32 v[140:141], v[196:197], v[26:27], v[140:141] op_sel_hi:[1,0,1]
  v_pk_fma_f32 v[142:143], v[198:199], v[26:27], v[142:143] op_sel_hi:[1,0,1]
  s_waitcnt lgkmcnt(4)
  v_pk_fma_f32 v[136:137], v[200:201], v[28:29], v[136:137] op_sel_hi:[1,0,1]
  v_pk_fma_f32 v[138:139], v[202:203], v[28:29], v[138:139] op_sel_hi:[1,0,1]
  v_pk_fma_f32 v[140:141], v[204:205], v[28:29], v[140:141] op_sel_hi:[1,0,1]
  v_pk_fma_f32 v[142:143], v[206:207], v[28:29], v[142:143] op_sel_hi:[1,0,1]
  s_waitcnt lgkmcnt(3)
  v_pk_fma_f32 v[136:137], v[208:209], v[30:31], v[136:137] op_sel_hi:[1,0,1]
  v_pk_fma_f32 v[138:139], v[210:211], v[30:31], v[138:139] op_sel_hi:[1,0,1]
  v_pk_fma_f32 v[140:141], v[212:213], v[30:31], v[140:141] op_sel_hi:[1,0,1]
  v_pk_fma_f32 v[142:143], v[214:215], v[30:31], v[142:143] op_sel_hi:[1,0,1]
  s_waitcnt lgkmcnt(2)
  v_pk_fma_f32 v[136:137], v[216:217], v[32:33], v[136:137] op_sel_hi:[1,0,1]
  v_pk_fma_f32 v[138:139], v[218:219], v[32:33], v[138:139] op_sel_hi:[1,0,1]
  v_pk_fma_f32 v[140:141], v[220:221], v[32:33], v[140:141] op_sel_hi:[1,0,1]
  v_pk_fma_f32 v[142:143], v[222:223], v[32:33], v[142:143] op_sel_hi:[1,0,1]
  s_waitcnt lgkmcnt(1)
  v_pk_fma_f32 v[136:137], v[224:225], v[34:35], v[136:137] op_sel_hi:[1,0,1]
  v_pk_fma_f32 v[138:139], v[226:227], v[34:35], v[138:139] op_sel_hi:[1,0,1]
  v_pk_fma_f32 v[140:141], v[228:229], v[34:35], v[140:141] op_sel_hi:[1,0,1]
  v_pk_fma_f32 v[142:143], v[230:231], v[34:35], v[142:143] op_sel_hi:[1,0,1]
  s_waitcnt lgkmcnt(0)
  v_pk_fma_f32 v[136:137], v[232:233], v[36:37], v[136:137] op_sel_hi:[1,0,1]
  v_pk_fma_f32 v[138:139], v[234:235], v[36:37], v[138:139] op_sel_hi:[1,0,1]
  v_pk_fma_f32 v[140:141], v[236:237], v[36:37], v[140:141] op_sel_hi:[1,0,1]
  v_pk_fma_f32 v[142:143], v[238:239], v[36:37], v[142:143] op_sel_hi:[1,0,1]
  v_mul_u32_u24 v13, 2304, v7
  v_lshl_add_u32 v13, v8, 5, v13
  v_cmp_gt_u32 vcc, 216, v0
  s_and_saveexec_b64 s[62:63], vcc
  ds_write_b128 v13, v[136:139] offset:4096
  ds_write_b128 v13, v[140:143] offset:4112
  s_mov_b64 exec, s[62:63]
  v_lshlrev_b32 v14, 2, v0
  s_and_b32 s68, s23, 7
  s_mul_i32 s68, s68, 2304
  s_add_u32 s68, s68, 15228928
  s_waitcnt lgkmcnt(0)
  s_barrier
  ds_read_b32 v16, v14 offset:4096
  ds_read_b32 v17, v14 offset:6400
  ds_read_b32 v18, v14 offset:8704
  ds_read_b32 v19, v14 offset:5120
  ds_read_b32 v20, v14 offset:7424
  ds_read_b32 v21, v14 offset:9728
  ds_read_b32 v22, v14 offset:6144
  ds_read_b32 v23, v14 offset:8448
  ds_read_b32 v24, v14 offset:10752
  s_waitcnt lgkmcnt(0)
  v_add_f32 v16, v16, v17
  v_add_f32 v16, v16, v18
  v_add_f32 v19, v19, v20
  v_add_f32 v19, v19, v21
  v_add_f32 v22, v22, v23
  v_add_f32 v22, v22, v24
  buffer_atomic_add_f32 v16, v14, s[8:11], s68 offen
  buffer_atomic_add_f32 v19, v14, s[8:11], s68 offen offset:1024
  s_cmp_lg_u32 s22, 0
  s_cbranch_scc1 p2_at3
  buffer_atomic_add_f32 v22, v14, s[8:11], s68 offen offset:2048
p2_at3:
  v_mul_f32 v67, 0x3ae38e39, v56
  v_mul_f32 v68, 0x3ae38e39, v58
  v_fma_f32 v68, -v67, v67, v68
  v_max_f32 v68, 0, v68
  v_cvt_pk_bf16_f32 v67, v67, v67
  v_cvt_pk_bf16_f32 v68, v68, v68
  v_and_b32 v67, 0xffff0000, v67
  v_and_b32 v68, 0xffff0000, v68
  v_add_f32 v68, 0x3727c5ac, v68
  v_cvt_pk_bf16_f32 v68, v68, v68
  v_and_b32 v68, 0xffff0000, v68
  v_sqrt_f32 v68, v68
  s_nop 0
  v_cvt_pk_bf16_f32 v68, v68, v68
  v_and_b32 v68, 0xffff0000, v68
  v_rcp_f32 v68, v68
  s_nop 0
  v_lshlrev_b32 v16, 16, v40
  v_and_b32 v17, 0xffff0000, v40
  v_lshlrev_b32 v18, 16, v41
  v_and_b32 v19, 0xffff0000, v41
  v_lshlrev_b32 v20, 16, v42
  v_and_b32 v21, 0xffff0000, v42
  v_lshlrev_b32 v22, 16, v43
  v_and_b32 v23, 0xffff0000, v43
  v_lshlrev_b32 v24, 16, v44
  v_and_b32 v25, 0xffff0000, v44
  v_lshlrev_b32 v26, 16, v45
  v_and_b32 v27, 0xffff0000, v45
  v_lshlrev_b32 v28, 16, v46
  v_and_b32 v29, 0xffff0000, v46
  v_lshlrev_b32 v30, 16, v47
  v_and_b32 v31, 0xffff0000, v47
  v_sub_f32 v132, v16, v67
  v_sub_f32 v133, v17, v67
  v_sub_f32 v134, v18, v67
  v_sub_f32 v135, v19, v67
  v_sub_f32 v136, v20, v67
  v_sub_f32 v137, v21, v67
  v_sub_f32 v138, v22, v67
  v_sub_f32 v139, v23, v67
  v_sub_f32 v140, v24, v67
  v_sub_f32 v141, v25, v67
  v_sub_f32 v142, v26, v67
  v_sub_f32 v143, v27, v67
  v_sub_f32 v144, v28, v67
  v_sub_f32 v145, v29, v67
  v_sub_f32 v146, v30, v67
  v_sub_f32 v147, v31, v67
  v_cvt_pk_bf16_f32 v32, v132, v133
  v_cvt_pk_bf16_f32 v33, v134, v135
  v_cvt_pk_bf16_f32 v34, v136, v137
  v_cvt_pk_bf16_f32 v35, v138, v139
  v_cvt_pk_bf16_f32 v36, v140, v141
  v_cvt_pk_bf16_f32 v37, v142, v143
  v_cvt_pk_bf16_f32 v38, v144, v145
  v_cvt_pk_bf16_f32 v39, v146, v147
  v_lshlrev_b32 v132, 16, v32
  v_and_b32 v133, 0xffff0000, v32
  v_lshlrev_b32 v134, 16, v33
  v_and_b32 v135, 0xffff0000, v33
  v_lshlrev_b32 v136, 16, v34
  v_and_b32 v137, 0xffff0000, v34
  v_lshlrev_b32 v138, 16, v35
  v_and_b32 v139, 0xffff0000, v35
  v_lshlrev_b32 v140, 16, v36
  v_and_b32 v141, 0xffff0000, v36
  v_lshlrev_b32 v142, 16, v37
  v_and_b32 v143, 0xffff0000, v37
  v_lshlrev_b32 v144, 16, v38
  v_and_b32 v145, 0xffff0000, v38
  v_lshlrev_b32 v146, 16, v39
  v_and_b32 v147, 0xffff0000, v39
  v_mul_f32 v132, v132, v68
  v_mul_f32 v133, v133, v68
  v_mul_f32 v134, v134, v68
  v_mul_f32 v135, v135, v68
  v_mul_f32 v136, v136, v68
  v_mul_f32 v137, v137, v68
  v_mul_f32 v138, v138, v68
  v_mul_f32 v139, v139, v68
  v_mul_f32 v140, v140, v68
  v_mul_f32 v141, v141, v68
  v_mul_f32 v142, v142, v68
  v_mul_f32 v143, v143, v68
  v_mul_f32 v144, v144, v68
  v_mul_f32 v145, v145, v68
  v_mul_f32 v146, v146, v68
  v_mul_f32 v147, v147, v68
  v_cvt_pk_bf16_f32 v32, v132, v133
  v_cvt_pk_bf16_f32 v33, v134, v135
  v_cvt_pk_bf16_f32 v34, v136, v137
  v_cvt_pk_bf16_f32 v35, v138, v139
  v_cvt_pk_bf16_f32 v36, v140, v141
  v_cvt_pk_bf16_f32 v37, v142, v143
  v_cvt_pk_bf16_f32 v38, v144, v145
  v_cvt_pk_bf16_f32 v39, v146, v147
  v_lshlrev_b32 v132, 16, v32
  v_and_b32 v133, 0xffff0000, v32
  v_lshlrev_b32 v134, 16, v33
  v_and_b32 v135, 0xffff0000, v33
  v_lshlrev_b32 v136, 16, v34
  v_and_b32 v137, 0xffff0000, v34
  v_lshlrev_b32 v138, 16, v35
  v_and_b32 v139, 0xffff0000, v35
  v_lshlrev_b32 v140, 16, v36
  v_and_b32 v141, 0xffff0000, v36
  v_lshlrev_b32 v142, 16, v37
  v_and_b32 v143, 0xffff0000, v37
  v_lshlrev_b32 v144, 16, v38
  v_and_b32 v145, 0xffff0000, v38
  v_lshlrev_b32 v146, 16, v39
  v_and_b32 v147, 0xffff0000, v39
  v_add_f32 v132, v132, v16
  v_add_f32 v133, v133, v17
  v_add_f32 v134, v134, v18
  v_add_f32 v135, v135, v19
  v_add_f32 v136, v136, v20
  v_add_f32 v137, v137, v21
  v_add_f32 v138, v138, v22
  v_add_f32 v139, v139, v23
  v_add_f32 v140, v140, v24
  v_add_f32 v141, v141, v25
  v_add_f32 v142, v142, v26
  v_add_f32 v143, v143, v27
  v_add_f32 v144, v144, v28
  v_add_f32 v145, v145, v29
  v_add_f32 v146, v146, v30
  v_add_f32 v147, v147, v31
  v_cvt_pk_bf16_f32 v40, v132, v133
  v_cvt_pk_bf16_f32 v41, v134, v135
  v_cvt_pk_bf16_f32 v42, v136, v137
  v_cvt_pk_bf16_f32 v43, v138, v139
  v_cvt_pk_bf16_f32 v44, v140, v141
  v_cvt_pk_bf16_f32 v45, v142, v143
  v_cvt_pk_bf16_f32 v46, v144, v145
  v_cvt_pk_bf16_f32 v47, v146, v147
  s_add_u32 s57, s42, 0
  s_add_u32 s58, s43, 0
  s_cmp_eq_u32 s57, s53
  s_cselect_b32 s58, 1073741824, s58
  buffer_store_dwordx4 v[40:43], v4, s[28:31], s58 offen
  buffer_store_dwordx4 v[44:47], v5, s[28:31], s58 offen
  v_mul_f32 v67, 0x3ae38e39, v57
  v_mul_f32 v68, 0x3ae38e39, v59
  v_fma_f32 v68, -v67, v67, v68
  v_max_f32 v68, 0, v68
  v_cvt_pk_bf16_f32 v67, v67, v67
  v_cvt_pk_bf16_f32 v68, v68, v68
  v_and_b32 v67, 0xffff0000, v67
  v_and_b32 v68, 0xffff0000, v68
  v_add_f32 v68, 0x3727c5ac, v68
  v_cvt_pk_bf16_f32 v68, v68, v68
  v_and_b32 v68, 0xffff0000, v68
  v_sqrt_f32 v68, v68
  s_nop 0
  v_cvt_pk_bf16_f32 v68, v68, v68
  v_and_b32 v68, 0xffff0000, v68
  v_rcp_f32 v68, v68
  s_nop 0
  v_lshlrev_b32 v16, 16, v48
  v_and_b32 v17, 0xffff0000, v48
  v_lshlrev_b32 v18, 16, v49
  v_and_b32 v19, 0xffff0000, v49
  v_lshlrev_b32 v20, 16, v50
  v_and_b32 v21, 0xffff0000, v50
  v_lshlrev_b32 v22, 16, v51
  v_and_b32 v23, 0xffff0000, v51
  v_lshlrev_b32 v24, 16, v52
  v_and_b32 v25, 0xffff0000, v52
  v_lshlrev_b32 v26, 16, v53
  v_and_b32 v27, 0xffff0000, v53
  v_lshlrev_b32 v28, 16, v54
  v_and_b32 v29, 0xffff0000, v54
  v_lshlrev_b32 v30, 16, v55
  v_and_b32 v31, 0xffff0000, v55
  v_sub_f32 v132, v16, v67
  v_sub_f32 v133, v17, v67
  v_sub_f32 v134, v18, v67
  v_sub_f32 v135, v19, v67
  v_sub_f32 v136, v20, v67
  v_sub_f32 v137, v21, v67
  v_sub_f32 v138, v22, v67
  v_sub_f32 v139, v23, v67
  v_sub_f32 v140, v24, v67
  v_sub_f32 v141, v25, v67
  v_sub_f32 v142, v26, v67
  v_sub_f32 v143, v27, v67
  v_sub_f32 v144, v28, v67
  v_sub_f32 v145, v29, v67
  v_sub_f32 v146, v30, v67
  v_sub_f32 v147, v31, v67
  v_cvt_pk_bf16_f32 v32, v132, v133
  v_cvt_pk_bf16_f32 v33, v134, v135
  v_cvt_pk_bf16_f32 v34, v136, v137
  v_cvt_pk_bf16_f32 v35, v138, v139
  v_cvt_pk_bf16_f32 v36, v140, v141
  v_cvt_pk_bf16_f32 v37, v142, v143
  v_cvt_pk_bf16_f32 v38, v144, v145
  v_cvt_pk_bf16_f32 v39, v146, v147
  v_lshlrev_b32 v132, 16, v32
  v_and_b32 v133, 0xffff0000, v32
  v_lshlrev_b32 v134, 16, v33
  v_and_b32 v135, 0xffff0000, v33
  v_lshlrev_b32 v136, 16, v34
  v_and_b32 v137, 0xffff0000, v34
  v_lshlrev_b32 v138, 16, v35
  v_and_b32 v139, 0xffff0000, v35
  v_lshlrev_b32 v140, 16, v36
  v_and_b32 v141, 0xffff0000, v36
  v_lshlrev_b32 v142, 16, v37
  v_and_b32 v143, 0xffff0000, v37
  v_lshlrev_b32 v144, 16, v38
  v_and_b32 v145, 0xffff0000, v38
  v_lshlrev_b32 v146, 16, v39
  v_and_b32 v147, 0xffff0000, v39
  v_mul_f32 v132, v132, v68
  v_mul_f32 v133, v133, v68
  v_mul_f32 v134, v134, v68
  v_mul_f32 v135, v135, v68
  v_mul_f32 v136, v136, v68
  v_mul_f32 v137, v137, v68
  v_mul_f32 v138, v138, v68
  v_mul_f32 v139, v139, v68
  v_mul_f32 v140, v140, v68
  v_mul_f32 v141, v141, v68
  v_mul_f32 v142, v142, v68
  v_mul_f32 v143, v143, v68
  v_mul_f32 v144, v144, v68
  v_mul_f32 v145, v145, v68
  v_mul_f32 v146, v146, v68
  v_mul_f32 v147, v147, v68
  v_cvt_pk_bf16_f32 v32, v132, v133
  v_cvt_pk_bf16_f32 v33, v134, v135
  v_cvt_pk_bf16_f32 v34, v136, v137
  v_cvt_pk_bf16_f32 v35, v138, v139
  v_cvt_pk_bf16_f32 v36, v140, v141
  v_cvt_pk_bf16_f32 v37, v142, v143
  v_cvt_pk_bf16_f32 v38, v144, v145
  v_cvt_pk_bf16_f32 v39, v146, v147
  v_lshlrev_b32 v132, 16, v32
  v_and_b32 v133, 0xffff0000, v32
  v_lshlrev_b32 v134, 16, v33
  v_and_b32 v135, 0xffff0000, v33
  v_lshlrev_b32 v136, 16, v34
  v_and_b32 v137, 0xffff0000, v34
  v_lshlrev_b32 v138, 16, v35
  v_and_b32 v139, 0xffff0000, v35
  v_lshlrev_b32 v140, 16, v36
  v_and_b32 v141, 0xffff0000, v36
  v_lshlrev_b32 v142, 16, v37
  v_and_b32 v143, 0xffff0000, v37
  v_lshlrev_b32 v144, 16, v38
  v_and_b32 v145, 0xffff0000, v38
  v_lshlrev_b32 v146, 16, v39
  v_and_b32 v147, 0xffff0000, v39
  v_add_f32 v132, v132, v16
  v_add_f32 v133, v133, v17
  v_add_f32 v134, v134, v18
  v_add_f32 v135, v135, v19
  v_add_f32 v136, v136, v20
  v_add_f32 v137, v137, v21
  v_add_f32 v138, v138, v22
  v_add_f32 v139, v139, v23
  v_add_f32 v140, v140, v24
  v_add_f32 v141, v141, v25
  v_add_f32 v142, v142, v26
  v_add_f32 v143, v143, v27
  v_add_f32 v144, v144, v28
  v_add_f32 v145, v145, v29
  v_add_f32 v146, v146, v30
  v_add_f32 v147, v147, v31
  v_cvt_pk_bf16_f32 v48, v132, v133
  v_cvt_pk_bf16_f32 v49, v134, v135
  v_cvt_pk_bf16_f32 v50, v136, v137
  v_cvt_pk_bf16_f32 v51, v138, v139
  v_cvt_pk_bf16_f32 v52, v140, v141
  v_cvt_pk_bf16_f32 v53, v142, v143
  v_cvt_pk_bf16_f32 v54, v144, v145
  v_cvt_pk_bf16_f32 v55, v146, v147
  s_add_u32 s57, s42, 1
  s_add_u32 s58, s43, 1152
  s_cmp_eq_u32 s57, s53
  s_cselect_b32 s58, 1073741824, s58
  buffer_store_dwordx4 v[48:51], v4, s[28:31], s58 offen
  buffer_store_dwordx4 v[52:55], v5, s[28:31], s58 offen
  s_waitcnt vmcnt(4)
  s_barrier
  s_cmp_lg_u32 s22, 0
  s_cbranch_scc1 k34_end
  s_lshl_b32 s70, s23, 2
  s_add_u32 s70, s70, 15255680
  v_mov_b32 v14, 1
  s_mov_b64 exec, 1
  buffer_store_dword v14, v11, s[8:11], s70 offen sc1
  s_endpgm
p2_final:
  s_mov_b32 s70, 15255680
  s_mov_b32 s71, 0
  s_mov_b32 exec_lo, -1
  s_mov_b32 exec_hi, 0xf
p2_fpoll:
  buffer_load_dwordx4 v[16:19], v4, s[8:11], s70 offen sc1
  s_waitcnt vmcnt(0)
  v_and_b32 v16, v16, v17
  v_and_b32 v18, v18, v19
  v_and_b32 v16, v16, v18
  v_cmp_ne_u32 vcc, 1, v16
  s_add_u32 s71, s71, 1
  s_cmp_gt_u32 s71, 0x100000
  s_cbranch_vccz p2_fdone
  s_cbranch_scc1 p2_fdone
  s_sleep 4
  s_branch p2_fpoll
p2_fdone:
  s_mov_b64 exec, -1
  v_lshlrev_b32 v13, 1, v15
  s_mov_b32 s71, 15228928
  buffer_load_dwordx4 v[152:155], v13, s[8:11], s71 offen sc0 sc1
  buffer_load_dwordx4 v[156:159], v13, s[8:11], s71 offen offset:16 sc0 sc1
  s_add_u32 s71, s71, 2304
  buffer_load_dwordx4 v[160:163], v13, s[8:11], s71 offen sc0 sc1
  buffer_load_dwordx4 v[164:167], v13, s[8:11], s71 offen offset:16 sc0 sc1
  s_add_u32 s71, s71, 2304
  buffer_load_dwordx4 v[168:171], v13, s[8:11], s71 offen sc0 sc1
  buffer_load_dwordx4 v[172:175], v13, s[8:11], s71 offen offset:16 sc0 sc1
  s_add_u32 s71, s71, 2304
  buffer_load_dwordx4 v[176:179], v13, s[8:11], s71 offen sc0 sc1
  buffer_load_dwordx4 v[180:183], v13, s[8:11], s71 offen offset:16 sc0 sc1
  s_add_u32 s71, s71, 2304
  buffer_load_dwordx4 v[184:187], v13, s[8:11], s71 offen sc0 sc1
  buffer_load_dwordx4 v[188:191], v13, s[8:11], s71 offen offset:16 sc0 sc1
  s_add_u32 s71, s71, 2304
  buffer_load_dwordx4 v[192:195], v13, s[8:11], s71 offen sc0 sc1
  buffer_load_dwordx4 v[196:199], v13, s[8:11], s71 offen offset:16 sc0 sc1
  s_add_u32 s71, s71, 2304
  buffer_load_dwordx4 v[200:203], v13, s[8:11], s71 offen sc0 sc1
  buffer_load_dwordx4 v[204:207], v13, s[8:11], s71 offen offset:16 sc0 sc1
  s_add_u32 s71, s71, 2304
  buffer_load_dwordx4 v[208:211], v13, s[8:11], s71 offen sc0 sc1
  buffer_load_dwordx4 v[212:215], v13, s[8:11], s71 offen offset:16 sc0 sc1
  s_add_u32 s71, s71, 2304
  v_fma_f32 v10, -v69, s48, v66
  v_mul_f32 v10, v10, v70
  v_cvt_pk_bf16_f32 v10, v10, v10
  v_and_b32 v10, 0xffff0000, v10
  v_mul_f32 v10, 0xbfb8aa3b, v10
  v_exp_f32 v10, v10
  s_nop 0
  v_add_f32 v10, 1.0, v10
  v_rcp_f32 v10, v10
  s_nop 0
  v_cvt_pk_bf16_f32 v10, v10, v10
  v_and_b32 v10, 0xffff0000, v10
  s_waitcnt vmcnt(0)
  v_add_f32 v152, v152, v160
  v_add_f32 v153, v153, v161
  v_add_f32 v154, v154, v162
  v_add_f32 v155, v155, v163
  v_add_f32 v156, v156, v164
  v_add_f32 v157, v157, v165
  v_add_f32 v158, v158, v166
  v_add_f32 v159, v159, v167
  v_add_f32 v152, v152, v168
  v_add_f32 v153, v153, v169
  v_add_f32 v154, v154, v170
  v_add_f32 v155, v155, v171
  v_add_f32 v156, v156, v172
  v_add_f32 v157, v157, v173
  v_add_f32 v158, v158, v174
  v_add_f32 v159, v159, v175
  v_add_f32 v152, v152, v176
  v_add_f32 v153, v153, v177
  v_add_f32 v154, v154, v178
  v_add_f32 v155, v155, v179
  v_add_f32 v156, v156, v180
  v_add_f32 v157, v157, v181
  v_add_f32 v158, v158, v182
  v_add_f32 v159, v159, v183
  v_add_f32 v152, v152, v184
  v_add_f32 v153, v153, v185
  v_add_f32 v154, v154, v186
  v_add_f32 v155, v155, v187
  v_add_f32 v156, v156, v188
  v_add_f32 v157, v157, v189
  v_add_f32 v158, v158, v190
  v_add_f32 v159, v159, v191
  v_add_f32 v152, v152, v192
  v_add_f32 v153, v153, v193
  v_add_f32 v154, v154, v194
  v_add_f32 v155, v155, v195
  v_add_f32 v156, v156, v196
  v_add_f32 v157, v157, v197
  v_add_f32 v158, v158, v198
  v_add_f32 v159, v159, v199
  v_add_f32 v152, v152, v200
  v_add_f32 v153, v153, v201
  v_add_f32 v154, v154, v202
  v_add_f32 v155, v155, v203
  v_add_f32 v156, v156, v204
  v_add_f32 v157, v157, v205
  v_add_f32 v158, v158, v206
  v_add_f32 v159, v159, v207
  v_add_f32 v152, v152, v208
  v_add_f32 v153, v153, v209
  v_add_f32 v154, v154, v210
  v_add_f32 v155, v155, v211
  v_add_f32 v156, v156, v212
  v_add_f32 v157, v157, v213
  v_add_f32 v158, v158, v214
  v_add_f32 v159, v159, v215
  v_cvt_pk_bf16_f32 v40, v152, v153
  v_cvt_pk_bf16_f32 v41, v154, v155
  v_cvt_pk_bf16_f32 v42, v156, v157
  v_cvt_pk_bf16_f32 v43, v158, v159
  v_lshlrev_b32 v152, 16, v40
  v_and_b32 v153, 0xffff0000, v40
  v_lshlrev_b32 v154, 16, v41
  v_and_b32 v155, 0xffff0000, v41
  v_lshlrev_b32 v156, 16, v42
  v_and_b32 v157, 0xffff0000, v42
  v_lshlrev_b32 v158, 16, v43
  v_and_b32 v159, 0xffff0000, v43
  v_mul_f32 v152, v152, v10
  v_mul_f32 v153, v153, v10
  v_mul_f32 v154, v154, v10
  v_mul_f32 v155, v155, v10
  v_mul_f32 v156, v156, v10
  v_mul_f32 v157, v157, v10
  v_mul_f32 v158, v158, v10
  v_mul_f32 v159, v159, v10
  v_cvt_pk_bf16_f32 v40, v152, v153
  v_cvt_pk_bf16_f32 v41, v154, v155
  v_cvt_pk_bf16_f32 v42, v156, v157
  v_cvt_pk_bf16_f32 v43, v158, v159
  v_lshlrev_b32 v152, 16, v40
  v_and_b32 v153, 0xffff0000, v40
  v_lshlrev_b32 v154, 16, v41
  v_and_b32 v155, 0xffff0000, v41
  v_lshlrev_b32 v156, 16, v42
  v_and_b32 v157, 0xffff0000, v42
  v_lshlrev_b32 v158, 16, v43
  v_and_b32 v159, 0xffff0000, v43
  v_lshlrev_b32 v160, 16, v124
  v_and_b32 v161, 0xffff0000, v124
  v_lshlrev_b32 v162, 16, v125
  v_and_b32 v163, 0xffff0000, v125
  v_lshlrev_b32 v164, 16, v126
  v_and_b32 v165, 0xffff0000, v126
  v_lshlrev_b32 v166, 16, v127
  v_and_b32 v167, 0xffff0000, v127
  v_add_f32 v152, v152, v160
  v_add_f32 v153, v153, v161
  v_add_f32 v154, v154, v162
  v_add_f32 v155, v155, v163
  v_add_f32 v156, v156, v164
  v_add_f32 v157, v157, v165
  v_add_f32 v158, v158, v166
  v_add_f32 v159, v159, v167
  v_cvt_pk_bf16_f32 v40, v152, v153
  v_cvt_pk_bf16_f32 v41, v154, v155
  v_cvt_pk_bf16_f32 v42, v156, v157
  v_cvt_pk_bf16_f32 v43, v158, v159
  v_lshlrev_b32 v152, 16, v40
  v_and_b32 v153, 0xffff0000, v40
  v_lshlrev_b32 v154, 16, v41
  v_and_b32 v155, 0xffff0000, v41
  v_lshlrev_b32 v156, 16, v42
  v_and_b32 v157, 0xffff0000, v42
  v_lshlrev_b32 v158, 16, v43
  v_and_b32 v159, 0xffff0000, v43
  v_add_f32 v152, v152, v116
  v_add_f32 v153, v153, v117
  v_add_f32 v154, v154, v118
  v_add_f32 v155, v155, v119
  v_add_f32 v156, v156, v120
  v_add_f32 v157, v157, v121
  v_add_f32 v158, v158, v122
  v_add_f32 v159, v159, v123
  v_cvt_pk_bf16_f32 v40, v152, v153
  v_cvt_pk_bf16_f32 v41, v154, v155
  v_cvt_pk_bf16_f32 v42, v156, v157
  v_cvt_pk_bf16_f32 v43, v158, v159
  buffer_store_dwordx4 v[40:43], v15, s[28:31], s54 offen
k34_end:
  s_endpgm
.section .rodata,"a"
.p2align 6
.amdhsa_kernel k1_kernel
  .amdhsa_next_free_vgpr 208
  .amdhsa_next_free_sgpr 102
  .amdhsa_accum_offset 208
  .amdhsa_group_segment_fixed_size 0
  .amdhsa_kernarg_size 88
  .amdhsa_user_sgpr_count 2
  .amdhsa_user_sgpr_kernarg_segment_ptr 1
  .amdhsa_system_sgpr_workgroup_id_x 1
.end_amdhsa_kernel
.p2align 6
.amdhsa_kernel k2_kernel
  .amdhsa_next_free_vgpr 145
  .amdhsa_next_free_sgpr 64
  .amdhsa_accum_offset 148
  .amdhsa_group_segment_fixed_size 0
  .amdhsa_kernarg_size 88
  .amdhsa_user_sgpr_count 2
  .amdhsa_user_sgpr_kernarg_segment_ptr 1
  .amdhsa_system_sgpr_workgroup_id_x 1
.end_amdhsa_kernel
.p2align 6
.amdhsa_kernel k3_kernel
  .amdhsa_next_free_vgpr 256
  .amdhsa_next_free_sgpr 100
  .amdhsa_accum_offset 256
  .amdhsa_group_segment_fixed_size 0
  .amdhsa_kernarg_size 88
  .amdhsa_user_sgpr_count 2
  .amdhsa_user_sgpr_kernarg_segment_ptr 1
  .amdhsa_system_sgpr_workgroup_id_x 1
.end_amdhsa_kernel
```
